```python
import torch

def _softmax(x, axis=-1):
    return torch.softmax(x, dim=axis)
def _gelu(x):
    return torch.nn.functional.gelu(x, approximate="tanh")
def _silu(x):
    return torch.nn.functional.silu(x)
def _sigmoid(x):
    return torch.sigmoid(x)
def _layernorm(x, axis=-1, eps=1e-5):
    m = x.mean(dim=axis, keepdim=True)
    v = x.var(dim=axis, keepdim=True, unbiased=False)
    return (x - m) / torch.sqrt(v + eps)
def _scatter_add(tgt, idx, src, axis=0):
    return tgt.clone().index_add_(axis, idx, src)
def _segment_sum(src, seg, n):
    out = torch.zeros((n,) + src.shape[1:], dtype=src.dtype)
    return out.index_add_(0, seg, src)
def _pad(x, pw):
    flat = tuple(v for pair in reversed(pw) for v in pair)
    return torch.nn.functional.pad(x, flat)

kernel_name = 'standalone__edge_featured_mpnn_mpnn__graph'

def setup_inputs():

    _w = (lambda a: (lambda t: t.to(torch.bfloat16) if t.is_floating_point() else t)(torch.as_tensor(a)))
    N, deg, D, De = 10000, 64, 64, max(16, 1)
    E = N * deg
    H = 2 * D
    return {
        "x": _w((lambda *s: torch.randn(*s, dtype=torch.bfloat16) * 0.05)(N, D)),
        "e_attr": _w((lambda *s: torch.randn(*s, dtype=torch.bfloat16) * 0.8)(E, De)),
        "src": _w((lambda lo, hi, *s: torch.randint(lo, hi, s))(0, N, E).to(torch.int64)),
        "dst": _w((lambda lo, hi, *s: torch.randint(lo, hi, s))(0, N, E).to(torch.int64)),
        "w1": _w((lambda *s: torch.randn(*s, dtype=torch.bfloat16) * 0.8)(2 * D + De, H) * (1.0 / (2 * D + De) ** 0.5)),
        "b1": _w((lambda *s: torch.randn(*s, dtype=torch.bfloat16) * 0.4)(H) * 0.01),
        "w2": _w((lambda *s: torch.randn(*s, dtype=torch.bfloat16) * 0.05)(H, D) * (1.0 / H ** 0.5)),
        "b2": _w((lambda *s: torch.randn(*s, dtype=torch.bfloat16) * 0.05)(D) * 0.01),
    }

def reference(x, e_attr, src, dst, w1, b1, w2, b2):
    N, D = x.shape
    h_src = x[src]
    h_dst = x[dst]
    m_in = torch.concatenate([h_src, h_dst, e_attr], axis=-1)
    h = _silu(m_in @ w1 + b1)
    msg = h @ w2 + b2
    return _segment_sum(msg, dst, N)
```

```asm
; @launch grid=(256,1,1) block=(512,1,1) lds=163840
.amdgcn_target "amdgcn-amd-amdhsa--gfx950"
.text
.globl standalone__edge_featured_mpnn_mpnn__graph_kernel
.p2align 8
.type standalone__edge_featured_mpnn_mpnn__graph_kernel,@function
standalone__edge_featured_mpnn_mpnn__graph_kernel:
    s_cmp_ge_u32 s2, 256
    s_cbranch_scc1 K2_end
    s_load_dwordx4 s[80:83], s[0:1], 16
    s_load_dwordx4 s[84:87], s[0:1], 0
    s_load_dwordx8 s[60:67], s[0:1], 32
    s_load_dwordx4 s[88:91], s[0:1], 64
    s_load_dwordx2 s[46:47], s[0:1], 80
    v_lshrrev_b32 v2, 6, v0
    v_and_b32 v1, 63, v0
    v_readfirstlane_b32 s3, v2
    v_mul_u32_u24 v16, 40, v0
    s_movk_i32 s45, 250
    v_cmp_gt_u32 vcc, s45, v0
    v_mov_b32 v17, 0x40000000
    s_mul_i32 s28, s2, 10000
    v_cndmask_b32 v16, v17, v16, vcc
    s_mov_b64 s[48:49], vcc
    v_lshlrev_b32 v134, 2, v1
    v_lshlrev_b32 v18, 2, v0
    v_add_u32 v18, 65536, v18
    v_mov_b64 v[20:21], 0
    s_cmp_ge_u32 s3, 4
    s_cbranch_scc1 F_z1
    ds_write_b32 v18, v20 offset:0
    s_branch F_z2
F_z1:
    s_cmp_lg_u32 s3, 4
    s_cbranch_scc1 F_z2
    ds_write_b32 v134, v20 offset:0
    ds_write_b32 v134, v20 offset:256
    ds_write_b32 v134, v20 offset:768
    v_lshlrev_b32 v19, 3, v1
    ds_write_b64 v19, v[20:21] offset:22144
F_z2:
    s_waitcnt lgkmcnt(0)
    s_mov_b32 s72, s82
    s_and_b32 s73, s83, 0xffff
    s_mov_b32 s74, 2560000
    s_mov_b32 s75, 0x20000
    s_mov_b32 s68, s80
    s_and_b32 s69, s81, 0xffff
    s_mov_b32 s70, 2560000
    s_mov_b32 s71, 0x20000
    s_cmp_ge_u32 s3, 4
    s_cbranch_scc1 F_noload
    buffer_load_dwordx4 v[44:47], v16, s[72:75], s28 offen
    buffer_load_dwordx4 v[48:51], v16, s[72:75], s28 offen offset:16
    buffer_load_dwordx2 v[52:53], v16, s[72:75], s28 offen offset:32
    buffer_load_dwordx4 v[56:59], v16, s[68:71], s28 offen
    buffer_load_dwordx4 v[60:63], v16, s[68:71], s28 offen offset:16
    buffer_load_dwordx2 v[64:65], v16, s[68:71], s28 offen offset:32
F_noload:
    v_mov_b32 v140, 0
    s_barrier
    s_mov_b32 s12, s46
    s_and_b32 s13, s47, 0xffff
    s_mov_b32 s14, 3145728
    s_mov_b32 s15, 0x20000
    s_mov_b32 s4, s84
    s_and_b32 s5, s85, 0xffff
    s_mov_b32 s6, 1280000
    s_mov_b32 s7, 0x20000
    s_mov_b32 s8, s86
    s_and_b32 s9, s87, 0xffff
    s_mov_b32 s10, 20480000
    s_mov_b32 s11, 0x20000
    s_mov_b32 s24, s66
    s_and_b32 s25, s67, 0xffff
    s_mov_b32 s26, 128
    s_mov_b32 s27, 0x20000
    s_mov_b32 s16, s88
    s_and_b32 s17, s89, 0xffff
    s_mov_b32 s18, 1280000
    s_mov_b32 s19, 0x20000
    s_mov_b64 s[76:77], s[90:91]
    s_and_b32 s28, s2, 7
    s_lshl_b32 s28, s28, 5
    s_lshr_b32 s45, s2, 3
    s_add_u32 s28, s28, s45
    s_mov_b32 s31, 0
    s_mov_b32 s32, 0
    s_mov_b32 s33, 0
    s_mov_b32 s34, 1
    s_mov_b32 s101, 0
    s_mul_i32 s29, s28, 625
    s_add_u32 s30, s29, 640
    s_add_u32 s29, s29, 15
    s_lshr_b32 s29, s29, 4
    s_lshr_b32 s30, s30, 4
    s_sub_u32 s30, s30, s29
    s_and_b32 s56, s3, 3
    s_movk_i32 s42, 128
    s_movk_i32 s43, 0xfc
    s_movk_i32 s44, 16384
    s_movk_i32 s99, 528
    s_movk_i32 s100, 1040
    s_lshl_b32 s36, s56, 13
    s_add_u32 s36, s36, 98304
    s_add_u32 s37, s36, 4096
    s_lshl_b32 s40, s3, 11
    s_add_u32 s40, s40, 131072
    s_add_u32 s41, s40, 1024
    v_and_b32 v131, 31, v1
    v_lshrrev_b32 v132, 5, v1
    v_lshlrev_b32 v130, 4, v1
    s_cmp_lt_u32 s3, 4
    s_cbranch_scc1 F_nodma
    s_lshl_b32 s80, s2, 3
    s_add_u32 s80, s80, s3
    s_cmp_lg_u32 s80, 4
    s_cbranch_scc1 F_notag
    s_memrealtime s[78:79]
    v_lshlrev_b32 v133, 7, v1
    s_waitcnt lgkmcnt(0)
    s_or_b32 s78, s78, 1
    v_mov_b32 v20, s78
    v_mov_b32 v21, s79
    s_mov_b64 exec, 3
    global_store_dwordx2 v133, v[20:21], s[76:77] sc1
    s_mov_b64 exec, -1
F_notag:
    v_lshlrev_b32 v133, 7, v1
    s_lshr_b32 s80, s2, 3
    s_cmp_eq_u32 s3, 5
    s_cbranch_scc0 F_t1
    s_mov_b32 s20, s60
    s_and_b32 s21, s61, 0xffff
    s_mov_b32 s22, 36864
    s_mov_b32 s23, 0x20000
    s_mul_i32 s80, s80, 1152
    s_mov_b64 exec, 0x1ff
    buffer_load_dword v139, v133, s[20:23], s80 offen
F_t1:
    s_cmp_eq_u32 s3, 6
    s_cbranch_scc0 F_t2
    s_mov_b32 s20, s64
    s_and_b32 s21, s65, 0xffff
    s_mov_b32 s22, 16384
    s_mov_b32 s23, 0x20000
    s_lshl_b32 s80, s80, 9
    s_mov_b64 exec, 0xf
    buffer_load_dword v139, v133, s[20:23], s80 offen
F_t2:
    s_cmp_eq_u32 s3, 7
    s_cbranch_scc0 F_t3
    s_lshl_b32 s80, s29, 7
    s_mov_b32 exec_hi, 0xff
    buffer_load_dword v139, v133, s[4:7], s80 offen
F_t3:
    s_cmp_eq_u32 s3, 4
    s_cbranch_scc0 F_t4
    s_getpc_b64 s[82:83]
    s_mul_i32 s80, s80, 512
    s_add_u32 s82, s82, s80
    s_addc_u32 s83, s83, 0
    s_mov_b64 exec, 0xf
    global_load_dword v139, v133, s[82:83]
F_t4:
    s_mov_b64 exec, -1
    s_barrier
    s_cmp_lg_u32 s3, 4
    s_cbranch_scc1 F_notag2
    s_and_b32 s80, s2, 1
    s_lshl_b32 s80, s80, 7
    v_mov_b32 v140, s80
    global_load_dwordx2 v[142:143], v140, s[76:77] sc1
F_notag2:
    s_mov_b32 s20, s60
    s_and_b32 s21, s61, 0xffff
    s_mov_b32 s22, 36864
    s_mov_b32 s23, 0x20000
    v_lshrrev_b32 v133, 2, v1
    v_and_b32 v135, 3, v1
    v_lshlrev_b32 v135, 4, v135
    v_lshl_add_u32 v133, v133, 8, v135
    s_lshl_b32 s82, s56, 6
    s_mul_i32 s83, s56, 9216
    s_add_u32 s83, s83, 98304
    s_add_u32 m0, s83, 0
    s_add_u32 s84, s82, 0
    buffer_load_dwordx4 v133, s[20:23], s84 offen lds
    s_add_u32 m0, s83, 1024
    s_add_u32 s84, s82, 4096
    buffer_load_dwordx4 v133, s[20:23], s84 offen lds
    s_add_u32 m0, s83, 2048
    s_add_u32 s84, s82, 8192
    buffer_load_dwordx4 v133, s[20:23], s84 offen lds
    s_add_u32 m0, s83, 3072
    s_add_u32 s84, s82, 12288
    buffer_load_dwordx4 v133, s[20:23], s84 offen lds
    s_add_u32 m0, s83, 8192
    s_add_u32 s84, s82, 32768
    buffer_load_dwordx4 v133, s[20:23], s84 offen lds
    v_mov_b32 v129, v133
    v_lshrrev_b32 v135, 4, v0
    v_xor_b32 v135, v135, v0
    v_and_b32 v135, 7, v135
    v_lshrrev_b32 v128, 3, v1
    v_lshlrev_b32 v135, 4, v135
    v_lshl_add_u32 v135, v128, 7, v135
    s_lshl_b32 s85, s56, 10
    s_lshl_b32 s86, s29, 7
    s_add_u32 m0, s85, 135168
    s_add_u32 s87, s86, s85
    buffer_load_dwordx4 v135, s[4:7], s87 offen lds
    s_and_b32 s87, s56, 1
    s_lshl_b32 s87, s87, 6
    v_xor_b32 v135, s87, v135
    s_mov_b32 m0, 139264
    s_add_u32 s87, s86, 4096
    buffer_load_dwordx4 v135, s[4:7], s87 offen lds
    s_barrier
    s_branch F_setup
F_nodma:
    s_mov_b32 s80, 429497
    s_movk_i32 s81, 625
    s_mov_b32 s88, 65536
    v_mov_b32 v17, 1
    v_mul_u32_u24 v19, 10, v0
    v_add_u32 v18, 65536, v130
    s_mov_b64 exec, s[48:49]
    s_waitcnt vmcnt(5)
    v_mul_u32_u24 v68, s80, v44
    v_mul_u32_u24 v69, s80, v45
    v_mul_u32_u24 v70, s80, v46
    v_mul_u32_u24 v71, s80, v47
    v_lshrrev_b32 v80, 24, v68
    v_lshrrev_b32 v81, 24, v69
    v_lshrrev_b32 v82, 24, v70
    v_lshrrev_b32 v83, 24, v71
    v_lshl_add_u32 v68, v80, 2, s88
    v_lshl_add_u32 v69, v81, 2, s88
    v_lshl_add_u32 v70, v82, 2, s88
    v_lshl_add_u32 v71, v83, 2, s88
    ds_add_rtn_u32 v92, v68, v17 offset:0
    ds_add_rtn_u32 v93, v69, v17 offset:0
    ds_add_rtn_u32 v94, v70, v17 offset:0
    ds_add_rtn_u32 v95, v71, v17 offset:0
    s_waitcnt vmcnt(4)
    v_mul_u32_u24 v72, s80, v48
    v_mul_u32_u24 v73, s80, v49
    v_mul_u32_u24 v74, s80, v50
    v_mul_u32_u24 v75, s80, v51
    v_lshrrev_b32 v84, 24, v72
    v_lshrrev_b32 v85, 24, v73
    v_lshrrev_b32 v86, 24, v74
    v_lshrrev_b32 v87, 24, v75
    v_lshl_add_u32 v72, v84, 2, s88
    v_lshl_add_u32 v73, v85, 2, s88
    v_lshl_add_u32 v74, v86, 2, s88
    v_lshl_add_u32 v75, v87, 2, s88
    ds_add_rtn_u32 v96, v72, v17 offset:0
    ds_add_rtn_u32 v97, v73, v17 offset:0
    ds_add_rtn_u32 v98, v74, v17 offset:0
    ds_add_rtn_u32 v99, v75, v17 offset:0
    s_waitcnt vmcnt(3)
    v_mul_u32_u24 v76, s80, v52
    v_mul_u32_u24 v77, s80, v53
    v_lshrrev_b32 v88, 24, v76
    v_lshrrev_b32 v89, 24, v77
    v_lshl_add_u32 v76, v88, 2, s88
    v_lshl_add_u32 v77, v89, 2, s88
    ds_add_rtn_u32 v100, v76, v17 offset:0
    ds_add_rtn_u32 v101, v77, v17 offset:0
    s_mov_b64 exec, -1
    s_waitcnt lgkmcnt(0)
    s_barrier
    ds_read_b128 v[24:27], v18 offset:0
    s_waitcnt vmcnt(0)
    v_mad_u32_u24 v80, v80, s81, 15
    v_lshrrev_b32 v80, 4, v80
    v_sub_u32 v80, v44, v80
    v_add_u32 v44, 0, v19
    v_lshl_or_b32 v80, v80, 26, v44
    v_lshl_or_b32 v80, v56, 12, v80
    v_mad_u32_u24 v81, v81, s81, 15
    v_lshrrev_b32 v81, 4, v81
    v_sub_u32 v81, v45, v81
    v_add_u32 v45, 1, v19
    v_lshl_or_b32 v81, v81, 26, v45
    v_lshl_or_b32 v81, v57, 12, v81
    v_mad_u32_u24 v82, v82, s81, 15
    v_lshrrev_b32 v82, 4, v82
    v_sub_u32 v82, v46, v82
    v_add_u32 v46, 2, v19
    v_lshl_or_b32 v82, v82, 26, v46
    v_lshl_or_b32 v82, v58, 12, v82
    v_mad_u32_u24 v83, v83, s81, 15
    v_lshrrev_b32 v83, 4, v83
    v_sub_u32 v83, v47, v83
    v_add_u32 v47, 3, v19
    v_lshl_or_b32 v83, v83, 26, v47
    v_lshl_or_b32 v83, v59, 12, v83
    s_waitcnt lgkmcnt(0)
    v_add_u32 v29, v24, v25
    v_add_u32 v30, v29, v26
    v_add_u32 v31, v30, v27
    v_mov_b32 v28, v31
    v_mad_u32_u24 v84, v84, s81, 15
    v_lshrrev_b32 v84, 4, v84
    v_add_u32_dpp v28, v28, v28 row_shr:1 row_mask:0xf bank_mask:0xf
    v_sub_u32 v84, v48, v84
    v_add_u32 v48, 4, v19
    v_add_u32_dpp v28, v28, v28 row_shr:2 row_mask:0xf bank_mask:0xf
    v_lshl_or_b32 v84, v84, 26, v48
    v_lshl_or_b32 v84, v60, 12, v84
    v_add_u32_dpp v28, v28, v28 row_shr:4 row_mask:0xf bank_mask:0xf
    v_mad_u32_u24 v85, v85, s81, 15
    v_lshrrev_b32 v85, 4, v85
    v_add_u32_dpp v28, v28, v28 row_shr:8 row_mask:0xf bank_mask:0xf
    v_sub_u32 v85, v49, v85
    v_add_u32 v49, 5, v19
    v_add_u32_dpp v28, v28, v28 row_bcast:15 row_mask:0xa bank_mask:0xf
    v_lshl_or_b32 v85, v85, 26, v49
    v_lshl_or_b32 v85, v61, 12, v85
    v_add_u32_dpp v28, v28, v28 row_bcast:31 row_mask:0xc bank_mask:0xf
    v_sub_u32 v32, v28, v31
    v_add_u32 v33, v32, v24
    v_add_u32 v34, v32, v29
    v_add_u32 v35, v32, v30
    ds_write_b128 v18, v[32:35] offset:1024
    v_mad_u32_u24 v86, v86, s81, 15
    v_lshrrev_b32 v86, 4, v86
    v_sub_u32 v86, v50, v86
    v_add_u32 v50, 6, v19
    v_lshl_or_b32 v86, v86, 26, v50
    v_lshl_or_b32 v86, v62, 12, v86
    v_mad_u32_u24 v87, v87, s81, 15
    v_lshrrev_b32 v87, 4, v87
    v_sub_u32 v87, v51, v87
    v_add_u32 v51, 7, v19
    v_lshl_or_b32 v87, v87, 26, v51
    v_lshl_or_b32 v87, v63, 12, v87
    s_mov_b64 exec, s[48:49]
    s_waitcnt lgkmcnt(0)
    ds_read_b32 v68, v68 offset:1024
    ds_read_b32 v69, v69 offset:1024
    ds_read_b32 v70, v70 offset:1024
    ds_read_b32 v71, v71 offset:1024
    ds_read_b32 v72, v72 offset:1024
    ds_read_b32 v73, v73 offset:1024
    ds_read_b32 v74, v74 offset:1024
    ds_read_b32 v75, v75 offset:1024
    ds_read_b32 v76, v76 offset:1024
    ds_read_b32 v77, v77 offset:1024
    v_mad_u32_u24 v88, v88, s81, 15
    v_lshrrev_b32 v88, 4, v88
    v_sub_u32 v88, v52, v88
    v_add_u32 v52, 8, v19
    v_lshl_or_b32 v88, v88, 26, v52
    v_lshl_or_b32 v88, v64, 12, v88
    v_mad_u32_u24 v89, v89, s81, 15
    v_lshrrev_b32 v89, 4, v89
    v_sub_u32 v89, v53, v89
    v_add_u32 v53, 9, v19
    v_lshl_or_b32 v89, v89, 26, v53
    v_lshl_or_b32 v89, v65, 12, v89
    s_waitcnt lgkmcnt(9)
    v_add_u32 v68, v68, v92
    v_lshl_add_u32 v68, v68, 2, s88
    s_waitcnt lgkmcnt(8)
    v_add_u32 v69, v69, v93
    v_lshl_add_u32 v69, v69, 2, s88
    s_waitcnt lgkmcnt(7)
    v_add_u32 v70, v70, v94
    v_lshl_add_u32 v70, v70, 2, s88
    s_waitcnt lgkmcnt(6)
    v_add_u32 v71, v71, v95
    v_lshl_add_u32 v71, v71, 2, s88
    s_waitcnt lgkmcnt(5)
    v_add_u32 v72, v72, v96
    v_lshl_add_u32 v72, v72, 2, s88
    s_waitcnt lgkmcnt(4)
    v_add_u32 v73, v73, v97
    v_lshl_add_u32 v73, v73, 2, s88
    s_waitcnt lgkmcnt(3)
    v_add_u32 v74, v74, v98
    v_lshl_add_u32 v74, v74, 2, s88
    s_waitcnt lgkmcnt(2)
    v_add_u32 v75, v75, v99
    v_lshl_add_u32 v75, v75, 2, s88
    s_waitcnt lgkmcnt(1)
    v_add_u32 v76, v76, v100
    v_lshl_add_u32 v76, v76, 2, s88
    s_waitcnt lgkmcnt(0)
    v_add_u32 v77, v77, v101
    v_lshl_add_u32 v77, v77, 2, s88
    ds_write_b32 v68, v80 offset:2048
    ds_write_b32 v69, v81 offset:2048
    ds_write_b32 v70, v82 offset:2048
    ds_write_b32 v71, v83 offset:2048
    ds_write_b32 v72, v84 offset:2048
    ds_write_b32 v73, v85 offset:2048
    ds_write_b32 v74, v86 offset:2048
    ds_write_b32 v75, v87 offset:2048
    ds_write_b32 v76, v88 offset:2048
    ds_write_b32 v77, v89 offset:2048
    s_mov_b64 exec, -1
    s_waitcnt lgkmcnt(0)
    s_barrier
    v_lshlrev_b32 v16, 4, v0
    v_add_u32 v17, 65536, v16
    ds_read_b128 v[24:27], v17 offset:2048
    ds_read_b128 v[28:31], v17 offset:6144
    ds_read_b128 v[32:35], v17 offset:10240
    v_lshlrev_b32 v18, 2, v0
    v_add_u32 v18, 65536, v18
    ds_read_b32 v36, v18 offset:0
    ds_read_b32 v37, v18 offset:1024
    s_mul_i32 s80, s2, 10240
    s_movk_i32 s81, 113
    v_cmp_gt_u32 vcc, s81, v0
    s_add_u32 s81, s80, 4096
    s_add_u32 s82, s80, 8192
    s_waitcnt lgkmcnt(4)
    buffer_store_dwordx4 v[24:27], v16, s[12:15], s80 offen sc1
    s_waitcnt lgkmcnt(3)
    buffer_store_dwordx4 v[28:31], v16, s[12:15], s81 offen sc1
    s_waitcnt lgkmcnt(0)
    s_and_saveexec_b64 s[88:89], vcc
    s_cbranch_execz F_nost3
    buffer_store_dwordx4 v[32:35], v16, s[12:15], s82 offen sc1
F_nost3:
    s_mov_b64 exec, -1
    v_lshl_or_b32 v36, v36, 12, v37
    v_lshlrev_b32 v38, 3, v0
    s_lshl_b32 s80, s2, 11
    s_add_u32 s80, s80, 2621440
    v_mov_b32 v39, 0
    s_waitcnt vmcnt(0)
    s_barrier
    ds_read_b64 v[40:41], v39 offset:784
    s_waitcnt lgkmcnt(0)
    v_lshl_or_b32 v36, v41, 24, v36
    v_mov_b32 v37, v40
    buffer_store_dwordx2 v[36:37], v38, s[12:15], s80 offen sc1
    v_readfirstlane_b32 s78, v40
    v_readfirstlane_b32 s79, v41
    v_lshlrev_b32 v5, 2, v131
    v_lshlrev_b32 v13, 3, v131
    v_bfe_u32 v16, v1, 4, 1
    v_lshl_or_b32 v17, v132, 2, v16
    v_and_b32 v18, 7, v1
    v_xor_b32 v2, v17, v18
    v_lshlrev_b32 v2, 4, v2
    v_xor_b32 v3, 32, v2
    v_and_b32 v4, 1, v1
    v_xor_b32 v4, v4, v16
    v_lshlrev_b32 v4, 4, v4
    v_bfe_u32 v16, v131, 2, 1
    v_and_b32 v17, 1, v131
    v_lshrrev_b32 v18, 3, v131
    v_bfe_u32 v19, v131, 1, 1
    v_lshl_add_u32 v18, v18, 1, v19
    v_lshl_add_u32 v19, v16, 1, v17
    v_lshl_add_u32 v19, v19, 3, v18
    v_xor_b32 v10, v132, v17
    v_lshlrev_b32 v10, 4, v10
    v_lshl_add_u32 v10, v19, 5, v10
    v_add_u32 v10, s40, v10
    v_and_b32 v20, 3, v19
    v_lshrrev_b32 v19, 2, v19
    v_lshl_add_u32 v19, v20, 3, v19
    v_lshlrev_b32 v19, 7, v19
    v_add_u32 v19, s36, v19
    v_and_b32 v20, 7, v131
    v_xor_b32 v20, v20, v132
    v_lshl_add_u32 v6, v20, 4, v19
    v_xor_b32 v7, 32, v6
    v_xor_b32 v8, 64, v6
    v_xor_b32 v9, 0x60, v6
    v_cmp_eq_u32 vcc, v16, v132
    v_mov_b32 v14, 0x3f803f80
    v_bfe_u32 v11, v1, 3, 1
    v_cndmask_b32 v14, 0, v14, vcc
    v_cmp_eq_u32 vcc, 1, v17
    v_lshlrev_b32 v11, 4, v11
    v_bfe_u32 v12, v1, 1, 3
    v_cndmask_b32 v15, 0, v14, vcc
    v_cndmask_b32 v14, v14, 0, vcc
    v_lshlrev_b32 v12, 2, v12
    v_lshrrev_b32 v128, 2, v1
    s_lshl_b32 s45, s56, 6
    v_add_u32 v128, s45, v128
    v_and_b32 v129, 3, v1
    v_lshlrev_b32 v129, 2, v129
    v_lshrrev_b32 v127, 2, v129
    v_sub_u32 v127, v127, v129
    v_add_u32 v138, 20, v127
    v_add_u32 v127, 16, v127
    v_add_u32 v129, s32, v129
    s_movk_i32 s87, 2500
    v_mul_u32_u24 v116, s87, v128
    s_movk_i32 s87, 2560
    v_mad_u32_u24 v76, v128, s87, v129
    v_lshlrev_b32 v128, 11, v128
    v_add_u32 v117, 40000, v116
    v_add_u32 v77, 40960, v76
    v_add_u32 v118, 80000, v116
    v_add_u32 v78, 81920, v76
    v_add_u32 v119, 120000, v116
    v_add_u32 v79, 122880, v76
    v_mov_b32 v133, 0x40000000
    s_cmp_eq_u32 s56, s33
    s_cselect_b32 s88, -1, 0
    s_cmp_eq_u32 s31, 0
    s_cselect_b32 s88, -1, s88
    s_lshl_b32 s46, s28, 3
    s_add_u32 s46, s46, 2621440
    s_and_b32 s79, s79, 0xff
    s_cmp_eq_u32 s78, 0
    s_cbranch_scc1 F_timeout
K2_off:
    s_movk_i32 s89, 4000
    s_add_u32 s80, s46, 32768
    s_add_u32 s81, s46, 65536
    s_add_u32 s82, s46, 98304
F_poll:
    buffer_load_dwordx2 v[96:97], v128, s[12:15], s46 offen sc1
    buffer_load_dwordx2 v[98:99], v128, s[12:15], s80 offen sc1
    buffer_load_dwordx2 v[100:101], v128, s[12:15], s81 offen sc1
    buffer_load_dwordx2 v[102:103], v128, s[12:15], s82 offen sc1
    s_sub_u32 s89, s89, 1
    s_cbranch_scc1 F_timeout
    s_waitcnt vmcnt(3)
    v_xor_b32 v97, s78, v97
    v_lshrrev_b32 v104, 24, v96
    v_xor_b32 v104, s79, v104
    s_waitcnt vmcnt(2)
    v_xor_b32 v99, s78, v99
    v_lshrrev_b32 v105, 24, v98
    v_xor_b32 v105, s79, v105
    s_waitcnt vmcnt(1)
    v_xor_b32 v101, s78, v101
    v_lshrrev_b32 v106, 24, v100
    v_xor_b32 v106, s79, v106
    s_waitcnt vmcnt(0)
    v_xor_b32 v103, s78, v103
    v_lshrrev_b32 v107, 24, v102
    v_xor_b32 v107, s79, v107
    v_or3_b32 v97, v97, v99, v101
    v_or3_b32 v104, v104, v105, v106
    v_or3_b32 v97, v97, v103, v107
    v_or_b32 v97, v97, v104
    v_cmp_ne_u32 vcc, 0, v97
    s_cbranch_vccnz F_poll
K2_got:
    v_and_b32 v112, 0xfff, v96
    v_bfe_u32 v120, v96, 12, 12
    v_add_lshl_u32 v76, v76, v112, 2
    v_and_b32 v112, s88, v120
    v_sub_u32 v112, v112, v129
    v_cmp_lt_i32 vcc, 0, v112
    v_cmp_lt_i32 s[80:81], v127, v112
    v_lshl_add_u32 v80, v127, 2, v76
    v_cndmask_b32 v135, v133, v76, vcc
    buffer_load_dwordx4 v[36:39], v135, s[12:15], 0 offen sc1
    v_cndmask_b32 v80, v133, v80, s[80:81]
    v_cmp_lt_i32 s[48:49], 24, v112
    v_and_b32 v113, 0xfff, v98
    v_bfe_u32 v121, v98, 12, 12
    v_add_lshl_u32 v77, v77, v113, 2
    v_and_b32 v113, s88, v121
    v_sub_u32 v113, v113, v129
    v_cmp_lt_i32 vcc, 0, v113
    v_cmp_lt_i32 s[80:81], v127, v113
    v_lshl_add_u32 v81, v127, 2, v77
    v_cndmask_b32 v135, v133, v77, vcc
    buffer_load_dwordx4 v[40:43], v135, s[12:15], 0 offen sc1
    v_cndmask_b32 v81, v133, v81, s[80:81]
    v_cmp_lt_i32 s[50:51], 24, v113
    v_and_b32 v114, 0xfff, v100
    v_bfe_u32 v122, v100, 12, 12
    v_add_lshl_u32 v78, v78, v114, 2
    v_and_b32 v114, s88, v122
    v_sub_u32 v114, v114, v129
    v_cmp_lt_i32 vcc, 0, v114
    v_cmp_lt_i32 s[80:81], v127, v114
    v_lshl_add_u32 v82, v127, 2, v78
    v_cndmask_b32 v135, v133, v78, vcc
    buffer_load_dwordx4 v[44:47], v135, s[12:15], 0 offen sc1
    v_cndmask_b32 v82, v133, v82, s[80:81]
    v_cmp_lt_i32 s[52:53], 24, v114
    v_and_b32 v115, 0xfff, v102
    v_bfe_u32 v123, v102, 12, 12
    v_add_lshl_u32 v79, v79, v115, 2
    v_and_b32 v115, s88, v123
    v_sub_u32 v115, v115, v129
    v_cmp_lt_i32 vcc, 0, v115
    v_cmp_lt_i32 s[80:81], v127, v115
    v_lshl_add_u32 v83, v127, 2, v79
    v_cndmask_b32 v135, v133, v79, vcc
    buffer_load_dwordx4 v[48:51], v135, s[12:15], 0 offen sc1
    v_cndmask_b32 v83, v133, v83, s[80:81]
    v_cmp_lt_i32 s[54:55], 24, v115
    v_cmp_lt_i32 vcc, v138, v112
    buffer_load_dword v52, v80, s[12:15], 0 offen sc1
    s_nop 0
    v_cndmask_b32 v84, v133, v80, vcc
    v_cmp_lt_i32 vcc, v138, v113
    buffer_load_dword v53, v81, s[12:15], 0 offen sc1
    s_nop 0
    v_cndmask_b32 v85, v133, v81, vcc
    v_cmp_lt_i32 vcc, v138, v114
    buffer_load_dword v54, v82, s[12:15], 0 offen sc1
    s_nop 0
    v_cndmask_b32 v86, v133, v82, vcc
    v_cmp_lt_i32 vcc, v138, v115
    buffer_load_dword v55, v83, s[12:15], 0 offen sc1
    s_nop 0
    v_cndmask_b32 v87, v133, v83, vcc
    buffer_load_dword v108, v84, s[12:15], 0 offen offset:16 sc1
    buffer_load_dword v109, v85, s[12:15], 0 offen offset:16 sc1
    buffer_load_dword v110, v86, s[12:15], 0 offen offset:16 sc1
    buffer_load_dword v111, v87, s[12:15], 0 offen offset:16 sc1
    v_max_u32 v120, v120, v121
    v_max3_u32 v120, v120, v122, v123
    v_mov_b32 v121, 0
    s_cmp_eq_u32 s31, 0
    s_cbranch_scc1 K2_fastchk
    ds_max_u32 v121, v120 offset:772
    s_branch K2_chkdone
K2_fastchk:
    v_cmp_lt_u32 vcc, 40, v120
    s_cbranch_vccz K2_chkdone
    s_and_saveexec_b64 s[88:89], vcc
    v_mov_b32 v120, 0x100000
    ds_max_u32 v121, v120 offset:252
    s_mov_b64 exec, -1
K2_chkdone:
    v_mov_b32 v133, 4
    s_or_b64 s[80:81], s[48:49], s[50:51]
    s_or_b64 s[82:83], s[52:53], s[54:55]
    s_or_b64 s[80:81], s[80:81], s[82:83]
    s_cbranch_scc1 K2_rare1
K2_rare1r:
    s_waitcnt vmcnt(11)
    v_and_b32_sdwa v56, v36, s43 dst_sel:DWORD dst_unused:UNUSED_PAD src0_sel:BYTE_3 src1_sel:DWORD
    v_cmpx_lt_i32 vcc, 0, v112
    ds_add_rtn_u32 v16, v56, v133 offset:0
    v_and_b32_sdwa v57, v37, s43 dst_sel:DWORD dst_unused:UNUSED_PAD src0_sel:BYTE_3 src1_sel:DWORD
    v_cmpx_lt_i32 vcc, 1, v112
    ds_add_rtn_u32 v17, v57, v133 offset:0
    v_and_b32_sdwa v58, v38, s43 dst_sel:DWORD dst_unused:UNUSED_PAD src0_sel:BYTE_3 src1_sel:DWORD
    v_cmpx_lt_i32 vcc, 2, v112
    ds_add_rtn_u32 v18, v58, v133 offset:0
    v_and_b32_sdwa v59, v39, s43 dst_sel:DWORD dst_unused:UNUSED_PAD src0_sel:BYTE_3 src1_sel:DWORD
    v_cmpx_lt_i32 vcc, 3, v112
    ds_add_rtn_u32 v19, v59, v133 offset:0
    s_mov_b64 exec, -1
    s_waitcnt vmcnt(10)
    v_and_b32_sdwa v60, v40, s43 dst_sel:DWORD dst_unused:UNUSED_PAD src0_sel:BYTE_3 src1_sel:DWORD
    v_cmpx_lt_i32 vcc, 0, v113
    ds_add_rtn_u32 v20, v60, v133 offset:0
    v_and_b32_sdwa v61, v41, s43 dst_sel:DWORD dst_unused:UNUSED_PAD src0_sel:BYTE_3 src1_sel:DWORD
    v_cmpx_lt_i32 vcc, 1, v113
    ds_add_rtn_u32 v21, v61, v133 offset:0
    v_and_b32_sdwa v62, v42, s43 dst_sel:DWORD dst_unused:UNUSED_PAD src0_sel:BYTE_3 src1_sel:DWORD
    v_cmpx_lt_i32 vcc, 2, v113
    ds_add_rtn_u32 v22, v62, v133 offset:0
    v_and_b32_sdwa v63, v43, s43 dst_sel:DWORD dst_unused:UNUSED_PAD src0_sel:BYTE_3 src1_sel:DWORD
    v_cmpx_lt_i32 vcc, 3, v113
    ds_add_rtn_u32 v23, v63, v133 offset:0
    s_mov_b64 exec, -1
    s_waitcnt vmcnt(9)
    v_and_b32_sdwa v64, v44, s43 dst_sel:DWORD dst_unused:UNUSED_PAD src0_sel:BYTE_3 src1_sel:DWORD
    v_cmpx_lt_i32 vcc, 0, v114
    ds_add_rtn_u32 v24, v64, v133 offset:0
    v_and_b32_sdwa v65, v45, s43 dst_sel:DWORD dst_unused:UNUSED_PAD src0_sel:BYTE_3 src1_sel:DWORD
    v_cmpx_lt_i32 vcc, 1, v114
    ds_add_rtn_u32 v25, v65, v133 offset:0
    v_and_b32_sdwa v66, v46, s43 dst_sel:DWORD dst_unused:UNUSED_PAD src0_sel:BYTE_3 src1_sel:DWORD
    v_cmpx_lt_i32 vcc, 2, v114
    ds_add_rtn_u32 v26, v66, v133 offset:0
    v_and_b32_sdwa v67, v47, s43 dst_sel:DWORD dst_unused:UNUSED_PAD src0_sel:BYTE_3 src1_sel:DWORD
    v_cmpx_lt_i32 vcc, 3, v114
    ds_add_rtn_u32 v27, v67, v133 offset:0
    s_mov_b64 exec, -1
    s_waitcnt vmcnt(8)
    v_and_b32_sdwa v68, v48, s43 dst_sel:DWORD dst_unused:UNUSED_PAD src0_sel:BYTE_3 src1_sel:DWORD
    v_cmpx_lt_i32 vcc, 0, v115
    ds_add_rtn_u32 v28, v68, v133 offset:0
    v_and_b32_sdwa v69, v49, s43 dst_sel:DWORD dst_unused:UNUSED_PAD src0_sel:BYTE_3 src1_sel:DWORD
    v_cmpx_lt_i32 vcc, 1, v115
    ds_add_rtn_u32 v29, v69, v133 offset:0
    v_and_b32_sdwa v70, v50, s43 dst_sel:DWORD dst_unused:UNUSED_PAD src0_sel:BYTE_3 src1_sel:DWORD
    v_cmpx_lt_i32 vcc, 2, v115
    ds_add_rtn_u32 v30, v70, v133 offset:0
    v_and_b32_sdwa v71, v51, s43 dst_sel:DWORD dst_unused:UNUSED_PAD src0_sel:BYTE_3 src1_sel:DWORD
    v_cmpx_lt_i32 vcc, 3, v115
    ds_add_rtn_u32 v31, v71, v133 offset:0
    s_mov_b64 exec, -1
    s_waitcnt vmcnt(7)
    v_and_b32_sdwa v72, v52, s43 dst_sel:DWORD dst_unused:UNUSED_PAD src0_sel:BYTE_3 src1_sel:DWORD
    v_cmpx_lt_i32 vcc, v127, v112
    ds_add_rtn_u32 v32, v72, v133 offset:0
    v_cmpx_lt_i32 vcc, v138, v112
    s_cbranch_execz K2_s6a0
    s_waitcnt vmcnt(0)
    v_and_b32_sdwa v135, v108, s43 dst_sel:DWORD dst_unused:UNUSED_PAD src0_sel:BYTE_3 src1_sel:DWORD
    ds_add_rtn_u32 v140, v135, v133 offset:0
K2_s6a0:
    s_mov_b64 exec, -1
    s_waitcnt vmcnt(6)
    v_and_b32_sdwa v73, v53, s43 dst_sel:DWORD dst_unused:UNUSED_PAD src0_sel:BYTE_3 src1_sel:DWORD
    v_cmpx_lt_i32 vcc, v127, v113
    ds_add_rtn_u32 v33, v73, v133 offset:0
    v_cmpx_lt_i32 vcc, v138, v113
    s_cbranch_execz K2_s6a1
    s_waitcnt vmcnt(0)
    v_and_b32_sdwa v135, v109, s43 dst_sel:DWORD dst_unused:UNUSED_PAD src0_sel:BYTE_3 src1_sel:DWORD
    ds_add_rtn_u32 v141, v135, v133 offset:0
K2_s6a1:
    s_mov_b64 exec, -1
    s_waitcnt vmcnt(5)
    v_and_b32_sdwa v74, v54, s43 dst_sel:DWORD dst_unused:UNUSED_PAD src0_sel:BYTE_3 src1_sel:DWORD
    v_cmpx_lt_i32 vcc, v127, v114
    ds_add_rtn_u32 v34, v74, v133 offset:0
    v_cmpx_lt_i32 vcc, v138, v114
    s_cbranch_execz K2_s6a2
    s_waitcnt vmcnt(0)
    v_and_b32_sdwa v135, v110, s43 dst_sel:DWORD dst_unused:UNUSED_PAD src0_sel:BYTE_3 src1_sel:DWORD
    ds_add_rtn_u32 v142, v135, v133 offset:0
K2_s6a2:
    s_mov_b64 exec, -1
    s_waitcnt vmcnt(4)
    v_and_b32_sdwa v75, v55, s43 dst_sel:DWORD dst_unused:UNUSED_PAD src0_sel:BYTE_3 src1_sel:DWORD
    v_cmpx_lt_i32 vcc, v127, v115
    ds_add_rtn_u32 v35, v75, v133 offset:0
    v_cmpx_lt_i32 vcc, v138, v115
    s_cbranch_execz K2_s6a3
    s_waitcnt vmcnt(0)
    v_and_b32_sdwa v135, v111, s43 dst_sel:DWORD dst_unused:UNUSED_PAD src0_sel:BYTE_3 src1_sel:DWORD
    ds_add_rtn_u32 v143, v135, v133 offset:0
K2_s6a3:
    s_mov_b64 exec, -1
    s_waitcnt vmcnt(0)
    s_cmp_lg_u64 s[80:81], 0
    s_cbranch_scc1 K2_rare1b
K2_rare1br:
    s_cmp_lg_u32 s101, 0
    s_cbranch_scc1 F_nopf
    v_and_b32 v129, 0xff, v0
    v_lshlrev_b32 v129, 7, v129
    s_lshr_b32 s84, s2, 3
    s_mul_i32 s84, s84, 40064
    buffer_load_dword v139, v129, s[4:7], s84 offen
    s_add_u32 s84, s84, 7296
    buffer_load_dword v139, v129, s[4:7], s84 offen
F_nopf:
    s_mov_b64 exec, -1
    v_and_b32 v76, 0xfff, v36
    v_bfe_u32 v36, v36, 12, 14
    v_add_u32 v76, v76, v116
    v_mad_u32_u24 v36, v56, s44, v36
    v_and_b32 v77, 0xfff, v37
    v_bfe_u32 v37, v37, 12, 14
    v_add_u32 v77, v77, v116
    v_mad_u32_u24 v37, v57, s44, v37
    v_and_b32 v78, 0xfff, v38
    v_bfe_u32 v38, v38, 12, 14
    v_add_u32 v78, v78, v116
    v_mad_u32_u24 v38, v58, s44, v38
    v_and_b32 v79, 0xfff, v39
    v_bfe_u32 v39, v39, 12, 14
    v_add_u32 v79, v79, v116
    v_mad_u32_u24 v39, v59, s44, v39
    v_and_b32 v80, 0xfff, v40
    v_bfe_u32 v40, v40, 12, 14
    v_add_u32 v80, v80, v117
    v_mad_u32_u24 v40, v60, s44, v40
    v_and_b32 v81, 0xfff, v41
    v_bfe_u32 v41, v41, 12, 14
    v_add_u32 v81, v81, v117
    v_mad_u32_u24 v41, v61, s44, v41
    v_and_b32 v82, 0xfff, v42
    v_bfe_u32 v42, v42, 12, 14
    v_add_u32 v82, v82, v117
    v_mad_u32_u24 v42, v62, s44, v42
    v_and_b32 v83, 0xfff, v43
    v_bfe_u32 v43, v43, 12, 14
    v_add_u32 v83, v83, v117
    v_mad_u32_u24 v43, v63, s44, v43
    v_and_b32 v84, 0xfff, v44
    v_bfe_u32 v44, v44, 12, 14
    v_add_u32 v84, v84, v118
    v_mad_u32_u24 v44, v64, s44, v44
    v_and_b32 v85, 0xfff, v45
    v_bfe_u32 v45, v45, 12, 14
    v_add_u32 v85, v85, v118
    v_mad_u32_u24 v45, v65, s44, v45
    v_and_b32 v86, 0xfff, v46
    v_bfe_u32 v46, v46, 12, 14
    v_add_u32 v86, v86, v118
    v_mad_u32_u24 v46, v66, s44, v46
    v_and_b32 v87, 0xfff, v47
    v_bfe_u32 v47, v47, 12, 14
    v_add_u32 v87, v87, v118
    v_mad_u32_u24 v47, v67, s44, v47
    v_and_b32 v88, 0xfff, v48
    v_bfe_u32 v48, v48, 12, 14
    v_add_u32 v88, v88, v119
    v_mad_u32_u24 v48, v68, s44, v48
    v_and_b32 v89, 0xfff, v49
    v_bfe_u32 v49, v49, 12, 14
    v_add_u32 v89, v89, v119
    v_mad_u32_u24 v49, v69, s44, v49
    s_waitcnt lgkmcnt(0)
    s_barrier
    ds_read_b32 v124, v134 offset:0
    v_and_b32 v90, 0xfff, v50
    v_bfe_u32 v50, v50, 12, 14
    v_add_u32 v90, v90, v119
    v_mad_u32_u24 v50, v70, s44, v50
    v_and_b32 v91, 0xfff, v51
    v_bfe_u32 v51, v51, 12, 14
    v_add_u32 v91, v91, v119
    v_mad_u32_u24 v51, v71, s44, v51
    v_and_b32 v92, 0xfff, v52
    v_bfe_u32 v52, v52, 12, 14
    v_add_u32 v92, v92, v116
    v_mad_u32_u24 v52, v72, s44, v52
    s_waitcnt lgkmcnt(0)
    v_add_u32 v125, 28, v124
    v_and_b32 v125, -32, v125
    v_mov_b32 v126, v125
    v_and_b32 v93, 0xfff, v53
    v_bfe_u32 v53, v53, 12, 14
    v_add_u32_dpp v126, v126, v126 row_shr:1 row_mask:0xf bank_mask:0xf
    v_add_u32 v93, v93, v117
    v_mad_u32_u24 v53, v73, s44, v53
    v_add_u32_dpp v126, v126, v126 row_shr:2 row_mask:0xf bank_mask:0xf
    v_and_b32 v94, 0xfff, v54
    v_bfe_u32 v54, v54, 12, 14
    v_add_u32_dpp v126, v126, v126 row_shr:4 row_mask:0xf bank_mask:0xf
    v_add_u32 v94, v94, v118
    v_mad_u32_u24 v54, v74, s44, v54
    v_add_u32_dpp v126, v126, v126 row_shr:8 row_mask:0xf bank_mask:0xf
    v_and_b32 v95, 0xfff, v55
    v_bfe_u32 v55, v55, 12, 14
    v_add_u32_dpp v126, v126, v126 row_bcast:15 row_mask:0xa bank_mask:0xf
    v_add_u32 v95, v95, v119
    v_mad_u32_u24 v55, v75, s44, v55
    v_add_u32_dpp v126, v126, v126 row_bcast:31 row_mask:0xc bank_mask:0xf
    s_nop 0
    v_readlane_b32 s89, v126, 63
    v_sub_u32 v126, v126, v125
    v_add_u32 v126, 65536, v126
    s_cmp_gt_u32 s89, 13312
    s_cbranch_scc1 K2_togeneral
    ds_bpermute_b32 v56, v56, v126
    ds_bpermute_b32 v57, v57, v126
    ds_bpermute_b32 v58, v58, v126
    ds_bpermute_b32 v59, v59, v126
    ds_bpermute_b32 v60, v60, v126
    ds_bpermute_b32 v61, v61, v126
    ds_bpermute_b32 v62, v62, v126
    ds_bpermute_b32 v63, v63, v126
    ds_bpermute_b32 v64, v64, v126
    ds_bpermute_b32 v65, v65, v126
    s_add_u32 s87, s89, 127
    s_lshr_b32 s86, s87, 7
    s_lshr_b32 s88, s86, 2
    s_and_b32 s87, s86, 3
    s_mul_i32 s90, s88, s56
    s_min_u32 s91, s56, s87
    s_add_u32 s90, s90, s91
    s_cmp_lt_u32 s56, s87
    s_addc_u32 s35, s88, 0
    ds_bpermute_b32 v66, v66, v126
    ds_bpermute_b32 v67, v67, v126
    ds_bpermute_b32 v68, v68, v126
    ds_bpermute_b32 v69, v69, v126
    ds_bpermute_b32 v70, v70, v126
    ds_bpermute_b32 v71, v71, v126
    ds_bpermute_b32 v72, v72, v126
    ds_bpermute_b32 v73, v73, v126
    ds_bpermute_b32 v74, v74, v126
    ds_bpermute_b32 v75, v75, v126
    s_waitcnt lgkmcnt(15)
    v_add_u32 v16, v16, v56
    v_add_u32 v17, v17, v57
    v_add_u32 v18, v18, v58
    v_add_u32 v19, v19, v59
    s_waitcnt lgkmcnt(12)
    v_add_u32 v20, v20, v60
    v_add_u32 v21, v21, v61
    v_add_u32 v22, v22, v62
    v_add_u32 v23, v23, v63
    s_waitcnt lgkmcnt(8)
    v_add_u32 v24, v24, v64
    v_add_u32 v25, v25, v65
    v_add_u32 v26, v26, v66
    v_add_u32 v27, v27, v67
    s_waitcnt lgkmcnt(4)
    v_add_u32 v28, v28, v68
    v_add_u32 v29, v29, v69
    v_add_u32 v30, v30, v70
    v_add_u32 v31, v31, v71
    s_waitcnt lgkmcnt(0)
    v_add_u32 v32, v32, v72
    v_add_u32 v33, v33, v73
    v_add_u32 v34, v34, v74
    v_add_u32 v35, v35, v75
    v_cmpx_lt_i32 vcc, 0, v112
    ds_write2st64_b32 v16, v36, v76 offset0:0 offset1:64
    v_cmpx_lt_i32 vcc, 1, v112
    ds_write2st64_b32 v17, v37, v77 offset0:0 offset1:64
    v_cmpx_lt_i32 vcc, 2, v112
    ds_write2st64_b32 v18, v38, v78 offset0:0 offset1:64
    v_cmpx_lt_i32 vcc, 3, v112
    ds_write2st64_b32 v19, v39, v79 offset0:0 offset1:64
    v_cmpx_lt_i32 vcc, v127, v112
    ds_write2st64_b32 v32, v52, v92 offset0:0 offset1:64
    v_cmpx_lt_i32 vcc, v138, v112
    s_cbranch_execz K2_s6b0
    s_mov_b64 exec, -1
    v_and_b32_sdwa v135, v108, s43 dst_sel:DWORD dst_unused:UNUSED_PAD src0_sel:BYTE_3 src1_sel:DWORD
    ds_bpermute_b32 v120, v135, v126
    v_and_b32 v121, 0xfff, v108
    v_bfe_u32 v108, v108, 12, 14
    v_add_u32 v121, v121, v116
    v_mad_u32_u24 v108, v135, s44, v108
    s_waitcnt lgkmcnt(0)
    v_add_u32 v140, v140, v120
    v_cmpx_lt_i32 vcc, v138, v112
    ds_write2st64_b32 v140, v108, v121 offset0:0 offset1:64
    s_waitcnt lgkmcnt(0)
K2_s6b0:
    s_mov_b64 exec, -1
    v_cmpx_lt_i32 vcc, 0, v113
    ds_write2st64_b32 v20, v40, v80 offset0:0 offset1:64
    v_cmpx_lt_i32 vcc, 1, v113
    ds_write2st64_b32 v21, v41, v81 offset0:0 offset1:64
    v_cmpx_lt_i32 vcc, 2, v113
    ds_write2st64_b32 v22, v42, v82 offset0:0 offset1:64
    v_cmpx_lt_i32 vcc, 3, v113
    ds_write2st64_b32 v23, v43, v83 offset0:0 offset1:64
    v_cmpx_lt_i32 vcc, v127, v113
    ds_write2st64_b32 v33, v53, v93 offset0:0 offset1:64
    v_cmpx_lt_i32 vcc, v138, v113
    s_cbranch_execz K2_s6b1
    s_mov_b64 exec, -1
    v_and_b32_sdwa v135, v109, s43 dst_sel:DWORD dst_unused:UNUSED_PAD src0_sel:BYTE_3 src1_sel:DWORD
    ds_bpermute_b32 v120, v135, v126
    v_and_b32 v121, 0xfff, v109
    v_bfe_u32 v109, v109, 12, 14
    v_add_u32 v121, v121, v117
    v_mad_u32_u24 v109, v135, s44, v109
    s_waitcnt lgkmcnt(0)
    v_add_u32 v141, v141, v120
    v_cmpx_lt_i32 vcc, v138, v113
    ds_write2st64_b32 v141, v109, v121 offset0:0 offset1:64
    s_waitcnt lgkmcnt(0)
K2_s6b1:
    s_mov_b64 exec, -1
    v_cmpx_lt_i32 vcc, 0, v114
    ds_write2st64_b32 v24, v44, v84 offset0:0 offset1:64
    v_cmpx_lt_i32 vcc, 1, v114
    ds_write2st64_b32 v25, v45, v85 offset0:0 offset1:64
    v_cmpx_lt_i32 vcc, 2, v114
    ds_write2st64_b32 v26, v46, v86 offset0:0 offset1:64
    v_cmpx_lt_i32 vcc, 3, v114
    ds_write2st64_b32 v27, v47, v87 offset0:0 offset1:64
    v_cmpx_lt_i32 vcc, v127, v114
    ds_write2st64_b32 v34, v54, v94 offset0:0 offset1:64
    v_cmpx_lt_i32 vcc, v138, v114
    s_cbranch_execz K2_s6b2
    s_mov_b64 exec, -1
    v_and_b32_sdwa v135, v110, s43 dst_sel:DWORD dst_unused:UNUSED_PAD src0_sel:BYTE_3 src1_sel:DWORD
    ds_bpermute_b32 v120, v135, v126
    v_and_b32 v121, 0xfff, v110
    v_bfe_u32 v110, v110, 12, 14
    v_add_u32 v121, v121, v118
    v_mad_u32_u24 v110, v135, s44, v110
    s_waitcnt lgkmcnt(0)
    v_add_u32 v142, v142, v120
    v_cmpx_lt_i32 vcc, v138, v114
    ds_write2st64_b32 v142, v110, v121 offset0:0 offset1:64
    s_waitcnt lgkmcnt(0)
K2_s6b2:
    s_mov_b64 exec, -1
    v_cmpx_lt_i32 vcc, 0, v115
    ds_write2st64_b32 v28, v48, v88 offset0:0 offset1:64
    v_cmpx_lt_i32 vcc, 1, v115
    ds_write2st64_b32 v29, v49, v89 offset0:0 offset1:64
    v_cmpx_lt_i32 vcc, 2, v115
    ds_write2st64_b32 v30, v50, v90 offset0:0 offset1:64
    v_cmpx_lt_i32 vcc, 3, v115
    ds_write2st64_b32 v31, v51, v91 offset0:0 offset1:64
    v_cmpx_lt_i32 vcc, v127, v115
    ds_write2st64_b32 v35, v55, v95 offset0:0 offset1:64
    v_cmpx_lt_i32 vcc, v138, v115
    s_cbranch_execz K2_s6b3
    s_mov_b64 exec, -1
    v_and_b32_sdwa v135, v111, s43 dst_sel:DWORD dst_unused:UNUSED_PAD src0_sel:BYTE_3 src1_sel:DWORD
    ds_bpermute_b32 v120, v135, v126
    v_and_b32 v121, 0xfff, v111
    v_bfe_u32 v111, v111, 12, 14
    v_add_u32 v121, v121, v119
    v_mad_u32_u24 v111, v135, s44, v111
    s_waitcnt lgkmcnt(0)
    v_add_u32 v143, v143, v120
    v_cmpx_lt_i32 vcc, v138, v115
    ds_write2st64_b32 v143, v111, v121 offset0:0 offset1:64
    s_waitcnt lgkmcnt(0)
K2_s6b3:
    s_mov_b64 exec, -1
    s_cmp_lg_u64 s[80:81], 0
    s_cbranch_scc1 K2_rare2
K2_rare2r:
    s_lshl_b32 s90, s90, 7
    s_add_u32 s90, s90, 65536
    s_lshl_b32 s91, s35, 5
    v_lshrrev_b32 v128, 4, v1
    v_mul_u32_u24 v128, s91, v128
    v_add3_u32 v11, v11, v128, s90
    v_add3_u32 v12, v12, v128, s90
    v_add_u32 v132, 1024, v2
    v_mov_b32 v133, v3
    v_add_u32 v2, 3072, v2
    v_add_u32 v3, 2048, v3
    s_sub_u32 s20, s4, 3072
    s_subb_u32 s21, s5, 0
    s_mov_b32 s23, 0x20000
    s_waitcnt lgkmcnt(0)
    s_barrier
    ds_read_b128 v[24:27], v11
    ds_read_b32 v22, v12 offset:16384
    ds_read_b32 v128, v12 offset:16416
    ds_read_b128 v[36:39], v11 offset:32
    s_cmp_gt_u32 s35, 0
    s_cselect_b32 s22, 1283072, 0
    s_cmp_gt_u32 s35, 0
    s_cselect_b32 s10, 20480000, 0
    s_waitcnt lgkmcnt(2)
    v_lshl_add_u32 v22, v22, 5, v4
    s_mov_b32 m0, s40
    v_mov_b32 v18, v24
    v_mov_b32 v19, v24
    v_mad_u32_u16 v24, v24, s42, v2
    v_mad_u32_u16 v25, v25, s42, v3
    buffer_load_dwordx4 v22, s[8:11], 0 offen  lds
    s_mov_b32 m0, s36
    v_permlane16_swap_b32 v18, v19
    v_mad_u32_u16 v26, v26, s42, v132
    v_mad_u32_u16 v27, v27, s42, v133
    buffer_load_dwordx4 v24, s[20:23], 0 offen offset:0 lds
    buffer_load_dwordx4 v25, s[20:23], 0 offen offset:1024 lds
    buffer_load_dwordx4 v26, s[20:23], 0 offen offset:2048 lds
    buffer_load_dwordx4 v27, s[20:23], 0 offen offset:3072 lds
    s_waitcnt lgkmcnt(0)
    v_lshl_add_u32 v22, v128, 5, v4
    s_mov_b32 m0, s41
    s_cmp_gt_u32 s35, 1
    s_cselect_b32 s10, 20480000, 0
    s_cmp_gt_u32 s35, 1
    s_cselect_b32 s22, 1283072, 0
    buffer_load_dwordx4 v22, s[8:11], 0 offen  lds
    s_mov_b32 m0, s37
    v_mov_b64 v[24:25], v[36:37]
    v_mov_b64 v[26:27], v[38:39]
    v_mov_b32 v20, v24
    v_mov_b32 v21, v24
    v_mad_u32_u16 v24, v24, s42, v2
    v_mad_u32_u16 v25, v25, s42, v3
    v_mad_u32_u16 v26, v26, s42, v132
    v_mad_u32_u16 v27, v27, s42, v133
    buffer_load_dwordx4 v24, s[20:23], 0 offen offset:0 lds
    buffer_load_dwordx4 v25, s[20:23], 0 offen offset:1024 lds
    buffer_load_dwordx4 v26, s[20:23], 0 offen offset:2048 lds
    buffer_load_dwordx4 v27, s[20:23], 0 offen offset:3072 lds
    ds_read_b128 v[24:27], v11 offset:64
    ds_read_b32 v22, v12 offset:16448
    v_mad_u32_u16 v128, v18, s99, v5 op_sel:[1,0,0,0]
    ds_read_b32 v104, v128 offset:1024
    ds_read_b32 v106, v128 offset:1152
    ds_read_b32 v108, v128 offset:1280
    ds_read_b32 v110, v128 offset:1408
    v_mad_u32_u16 v129, v19, s99, v5 op_sel:[1,0,0,0]
    ds_read_b32 v105, v129 offset:1024
    ds_read_b32 v107, v129 offset:1152
    ds_read_b32 v109, v129 offset:1280
    ds_read_b32 v111, v129 offset:1408
    s_cmp_lg_u32 s101, 0
    s_cbranch_scc1 K2_now
    ds_read_b128 a[0:3], v130 offset:22784
    ds_read_b128 a[4:7], v130 offset:23808
    ds_read_b128 a[8:11], v130 offset:24832
    ds_read_b128 a[12:15], v130 offset:25856
    ds_read_b128 a[16:19], v130 offset:26880
    ds_read_b128 a[20:23], v130 offset:27904
    ds_read_b128 a[24:27], v130 offset:28928
    ds_read_b128 a[28:31], v130 offset:29952
    ds_read_b128 a[32:35], v130 offset:30976
    ds_read_b128 a[36:39], v130 offset:32000
    ds_read_b128 a[40:43], v130 offset:33024
    ds_read_b128 a[44:47], v130 offset:34048
    ds_read_b128 a[48:51], v130 offset:35072
    ds_read_b128 a[52:55], v130 offset:36096
    ds_read_b128 a[56:59], v130 offset:37120
    ds_read_b128 a[60:63], v130 offset:38144
    ds_read_b128 a[64:67], v130 offset:39168
    ds_read_b128 a[68:71], v130 offset:40192
    ds_read_b128 a[72:75], v130 offset:41216
    ds_read_b128 a[76:79], v130 offset:42240
    s_mov_b32 s101, 1
K2_now:
    v_mad_u32_u16 v16, v18, s100, v13 op_sel:[1,0,0,0]
    v_mad_u32_u16 v17, v19, s100, v13 op_sel:[1,0,0,0]
    v_mov_b64 v[28:29], 0
    v_mov_b32 v30, 1.0
    v_mov_b32 v31, 1.0
    v_mov_b32 v23, 1.0
    v_mov_b64 v[112:113], 0
    v_mov_b64 v[114:115], 0
    v_mov_b64 v[116:117], 0
    v_mov_b64 v[118:119], 0
    s_mov_b64 vcc, 0
    s_mov_b64 s[48:49], 0
    s_mov_b32 m0, s36
    s_waitcnt lgkmcnt(0)
    s_barrier
    v_mov_b32 v134, v24
    v_mov_b32 v135, v24
    v_mad_u32_u16 v24, v24, s42, v2
    v_mad_u32_u16 v25, v25, s42, v3
    v_mad_u32_u16 v26, v26, s42, v132
    v_mad_u32_u16 v27, v27, s42, v133
    v_lshl_add_u32 v22, v22, 5, v4
    s_cmp_gt_u32 s35, 2
    s_cselect_b32 s22, 1283072, 0
    s_cmp_gt_u32 s35, 2
    s_cselect_b32 s10, 20480000, 0
    s_waitcnt vmcnt(5)
    ds_read_b128 v[36:39], v6 offset:0
    ds_read_b128 v[40:43], v7 offset:0
    ds_read_b128 v[44:47], v8 offset:0
    ds_read_b128 v[48:51], v9 offset:0
    ds_read_b128 v[52:55], v10 offset:0
    s_barrier
    s_sub_u32 s35, s35, 1
    s_cbranch_scc1 K2_loop_done
    s_waitcnt lgkmcnt(0)
    v_mfma_f32_32x32x16_bf16 v[56:71], v[36:39], a[0:3], 0
    buffer_load_dwordx4 v24, s[20:23], 0 offen offset:0 lds
    v_mfma_f32_32x32x16_bf16 v[56:71], v[40:43], a[16:19], v[56:71]
    buffer_load_dwordx4 v25, s[20:23], 0 offen offset:1024 lds
    v_mfma_f32_32x32x16_bf16 v[56:71], v[44:47], a[32:35], v[56:71]
    buffer_load_dwordx4 v26, s[20:23], 0 offen offset:2048 lds
    v_mfma_f32_32x32x16_bf16 v[56:71], v[48:51], a[48:51], v[56:71]
    buffer_load_dwordx4 v27, s[20:23], 0 offen offset:3072 lds
    v_mfma_f32_32x32x16_bf16 v[56:71], v[52:55], a[64:67], v[56:71]
    s_mov_b32 m0, s40
    v_mfma_f32_32x32x8_bf16 v[56:71], v[14:15], v[104:105], v[56:71]
    s_nop 7
    s_cmp_eq_u32 s31, 0
    s_cbranch_scc0 K2_loopD
.p2align 6
K2_loopF:
    v_mfma_f32_32x32x16_bf16 v[72:87], v[36:39], a[4:7], 0
    buffer_load_dwordx4 v22, s[8:11], 0 offen  lds
    v_rcp_f32 v34, v30
    v_rcp_f32 v35, v31
    v_exp_f32_e64 v88, v56
    v_mfma_f32_32x32x16_bf16 v[72:87], v[40:43], a[20:23], v[72:87]
    ds_read_b128 v[24:27], v11 offset:96
    v_exp_f32 v89, v57
    v_exp_f32 v90, v58
    v_exp_f32_e64 v91, v59
    v_mfma_f32_32x32x16_bf16 v[72:87], v[44:47], a[36:39], v[72:87]
    ds_read_b32 v22, v12 offset:16480
    v_exp_f32 v92, v60
    v_exp_f32 v93, v61
    v_exp_f32_e64 v94, v62
    v_mfma_f32_32x32x16_bf16 v[72:87], v[48:51], a[52:55], v[72:87]
    s_mov_b32 m0, s37
    v_exp_f32 v95, v63
    v_exp_f32 v96, v64
    v_exp_f32 v97, v65
    v_mfma_f32_32x32x16_bf16 v[72:87], v[52:55], a[68:71], v[72:87]
    v_exp_f32 v98, v66
    v_exp_f32 v99, v67
    v_exp_f32_e64 v100, v68
    v_mfma_f32_32x32x8_bf16 v[72:87], v[14:15], v[106:107], v[72:87]
    s_waitcnt lgkmcnt(0)
    v_exp_f32 v101, v69
    v_exp_f32 v102, v70
    v_exp_f32 v103, v71
    v_max3_f32 v23, v23, v30, v31
    v_permlane16_swap_b32_e64 v20, v21
    v_mad_u32_u16 v25, v25, s42, v3
    v_mad_u32_u16 v26, v26, s42, v132
    v_pk_fma_f32 v[118:119], v[34:35], v[28:29], v[118:119]
    v_pk_add_f32 v[32:33], v[88:89], 1.0 op_sel_hi:[1,0]
    v_pk_fma_f32 v[28:29], v[56:57], v[90:91], v[56:57]
    v_pk_fma_f32 v[30:31], v[32:33], v[90:91], v[32:33]
    v_pk_fma_f32 v[28:29], v[58:59], v[32:33], v[28:29]
    v_pk_fma_f32 v[28:29], v[28:29], v[92:93], v[28:29]
    v_pk_fma_f32 v[32:33], v[30:31], v[92:93], v[30:31]
    v_pk_fma_f32 v[28:29], v[60:61], v[30:31], v[28:29]
    v_pk_fma_f32 v[28:29], v[28:29], v[94:95], v[28:29]
    v_pk_fma_f32 v[30:31], v[32:33], v[94:95], v[32:33]
    v_pk_fma_f32 v[28:29], v[62:63], v[32:33], v[28:29]
    v_pk_fma_f32 v[28:29], v[28:29], v[96:97], v[28:29]
    v_pk_fma_f32 v[32:33], v[30:31], v[96:97], v[30:31]
    v_pk_fma_f32 v[28:29], v[64:65], v[30:31], v[28:29]
    v_pk_fma_f32 v[28:29], v[28:29], v[98:99], v[28:29]
    v_pk_fma_f32 v[30:31], v[32:33], v[98:99], v[32:33]
    v_pk_fma_f32 v[28:29], v[66:67], v[32:33], v[28:29]
    v_pk_fma_f32 v[28:29], v[28:29], v[100:101], v[28:29]
    v_pk_fma_f32 v[32:33], v[30:31], v[100:101], v[30:31]
    v_pk_fma_f32 v[28:29], v[68:69], v[30:31], v[28:29]
    v_pk_fma_f32 v[28:29], v[28:29], v[102:103], v[28:29]
    v_pk_fma_f32 v[30:31], v[32:33], v[102:103], v[32:33]
    v_pk_fma_f32 v[28:29], v[70:71], v[32:33], v[28:29]
    v_mfma_f32_32x32x16_bf16 v[56:71], v[36:39], a[8:11], 0
    s_cbranch_vccz K2_flF00
    s_mov_b64 exec, vcc
    v_mad_u32_u16 v128, v18, s99, v5 op_sel:[1,0,0,0]
    v_cvt_f64_f32 v[120:121], v112
    v_cvt_f64_f32 v[122:123], v114
    v_cvt_f64_f32 v[124:125], v116
    v_cvt_f64_f32 v[126:127], v118
    ds_add_f64 v16, v[120:121] offset:22784
    ds_add_f64 v16, v[122:123] offset:23040
    ds_add_f64 v16, v[124:125] offset:23296
    ds_add_f64 v16, v[126:127] offset:23552
    ds_read_b32 v110, v128 offset:1408
    v_mov_b32 v112, 0
    v_mov_b32 v114, 0
    v_mov_b32 v116, 0
    v_mov_b32 v118, 0
    v_mad_u32_u16 v16, v18, s100, v13 op_sel:[1,0,0,0]
    s_mov_b64 exec, -1
K2_flF00:
    v_rcp_f32 v34, v30
    v_rcp_f32 v35, v31
    v_exp_f32 v88, v72
    v_mfma_f32_32x32x16_bf16 v[56:71], v[40:43], a[24:27], v[56:71]
    s_cmp_eq_u64 s[48:49], 0
    s_cbranch_scc1 K2_flF01
    s_mov_b64 exec, s[48:49]
    v_mad_u32_u16 v129, v19, s99, v5 op_sel:[1,0,0,0]
    v_cvt_f64_f32 v[120:121], v113
    v_cvt_f64_f32 v[122:123], v115
    v_cvt_f64_f32 v[124:125], v117
    v_cvt_f64_f32_e64 v[126:127], v119
    ds_add_f64 v17, v[120:121] offset:22784
    ds_add_f64 v17, v[122:123] offset:23040
    ds_add_f64 v17, v[124:125] offset:23296
    ds_add_f64 v17, v[126:127] offset:23552
    ds_read_b32 v111, v129 offset:1408
    v_mov_b32 v113, 0
    v_mov_b32 v115, 0
    v_mov_b32 v117, 0
    v_mov_b32 v119, 0
    v_mad_u32_u16 v17, v19, s100, v13 op_sel:[1,0,0,0]
    s_mov_b64 exec, -1
K2_flF01:
    v_exp_f32 v89, v73
    v_exp_f32 v90, v74
    v_exp_f32 v91, v75
    v_mfma_f32_32x32x16_bf16 v[56:71], v[44:47], a[40:43], v[56:71]
    s_cmp_gt_u32 s35, 2
    v_exp_f32 v92, v76
    v_exp_f32 v93, v77
    v_exp_f32 v94, v78
    v_mfma_f32_32x32x16_bf16 v[56:71], v[48:51], a[56:59], v[56:71]
    s_cselect_b32 s22, 1283072, 0
    v_exp_f32 v95, v79
    v_exp_f32 v96, v80
    v_exp_f32_e64 v97, v81
    v_mfma_f32_32x32x16_bf16 v[56:71], v[52:55], a[72:75], v[56:71]
    s_cselect_b32 s10, 20480000, 0
    v_exp_f32 v98, v82
    v_exp_f32 v99, v83
    v_exp_f32_e64 v100, v84
    v_mfma_f32_32x32x8_bf16 v[56:71], v[14:15], v[108:109], v[56:71]
    s_waitcnt vmcnt(5) lgkmcnt(0)
    v_exp_f32 v101, v85
    v_exp_f32 v102, v86
    v_exp_f32 v103, v87
    v_max3_f32 v23, v23, v30, v31
    v_cmp_ne_u32_sdwa vcc, v18, v20 src0_sel:WORD_1 src1_sel:WORD_1
    v_cmp_ne_u32_sdwa s[48:49], v19, v21 src0_sel:WORD_1 src1_sel:WORD_1
    v_mov_b64_e64 v[18:19], v[134:135]
    v_pk_fma_f32 v[112:113], v[34:35], v[28:29], v[112:113]
    v_pk_add_f32 v[32:33], v[88:89], 1.0 op_sel_hi:[1,0]
    v_pk_fma_f32 v[28:29], v[72:73], v[90:91], v[72:73]
    v_pk_fma_f32 v[30:31], v[32:33], v[90:91], v[32:33]
    v_pk_fma_f32 v[28:29], v[74:75], v[32:33], v[28:29]
    v_pk_fma_f32 v[28:29], v[28:29], v[92:93], v[28:29]
    v_pk_fma_f32 v[32:33], v[30:31], v[92:93], v[30:31]
    v_pk_fma_f32 v[28:29], v[76:77], v[30:31], v[28:29]
    v_pk_fma_f32 v[28:29], v[28:29], v[94:95], v[28:29]
    v_pk_fma_f32 v[30:31], v[32:33], v[94:95], v[32:33]
    v_pk_fma_f32 v[28:29], v[78:79], v[32:33], v[28:29]
    v_pk_fma_f32 v[28:29], v[28:29], v[96:97], v[28:29]
    v_pk_fma_f32 v[32:33], v[30:31], v[96:97], v[30:31]
    v_pk_fma_f32 v[28:29], v[80:81], v[30:31], v[28:29]
    v_pk_fma_f32 v[28:29], v[28:29], v[98:99], v[28:29]
    v_pk_fma_f32 v[30:31], v[32:33], v[98:99], v[32:33]
    v_pk_fma_f32 v[28:29], v[82:83], v[32:33], v[28:29]
    v_pk_fma_f32 v[28:29], v[28:29], v[100:101], v[28:29]
    v_pk_fma_f32 v[32:33], v[30:31], v[100:101], v[30:31]
    v_pk_fma_f32 v[28:29], v[84:85], v[30:31], v[28:29]
    v_pk_fma_f32 v[28:29], v[28:29], v[102:103], v[28:29]
    v_pk_fma_f32 v[30:31], v[32:33], v[102:103], v[32:33]
    v_pk_fma_f32 v[28:29], v[86:87], v[32:33], v[28:29]
    v_mfma_f32_32x32x16_bf16 v[72:87], v[36:39], a[12:15], 0
    s_cbranch_vccz K2_qlF00
    s_mov_b64 exec, vcc
    v_mad_u32_u16 v128, v20, s99, v5 op_sel:[1,0,0,0]
    ds_read_b32 v104, v128 offset:1024
    ds_read_b32 v106, v128 offset:1152
    ds_read_b32 v108, v128 offset:1280
    s_mov_b64 exec, -1
K2_qlF00:
    ds_read_b128 v[36:39], v6 offset:4096
    v_rcp_f32 v34, v30
    v_rcp_f32 v35, v31
    v_exp_f32 v88, v56
    v_mfma_f32_32x32x16_bf16 v[72:87], v[40:43], a[28:31], v[72:87]
    s_cmp_eq_u64 s[48:49], 0
    s_cbranch_scc1 K2_qlF01
    s_mov_b64 exec, s[48:49]
    v_mad_u32_u16 v129, v21, s99, v5 op_sel:[1,0,0,0]
    ds_read_b32 v105, v129 offset:1024
    ds_read_b32 v107, v129 offset:1152
    ds_read_b32 v109, v129 offset:1280
    s_mov_b64 exec, -1
K2_qlF01:
    ds_read_b128 v[40:43], v7 offset:4096
    v_exp_f32 v89, v57
    v_exp_f32 v90, v58
    v_exp_f32_e64 v91, v59
    v_mfma_f32_32x32x16_bf16 v[72:87], v[44:47], a[44:47], v[72:87]
    ds_read_b128 v[44:47], v8 offset:4096
    v_exp_f32 v92, v60
    v_exp_f32 v93, v61
    v_exp_f32_e64 v94, v62
    v_mfma_f32_32x32x16_bf16 v[72:87], v[48:51], a[60:63], v[72:87]
    ds_read_b128 v[48:51], v9 offset:4096
    v_exp_f32 v95, v63
    v_exp_f32 v96, v64
    v_exp_f32_e64 v97, v65
    v_mfma_f32_32x32x16_bf16 v[72:87], v[52:55], a[76:79], v[72:87]
    ds_read_b128 v[52:55], v10 offset:1024
    v_exp_f32 v98, v66
    v_exp_f32 v99, v67
    v_exp_f32_e64 v100, v68
    v_mfma_f32_32x32x8_bf16 v[72:87], v[14:15], v[110:111], v[72:87]
    s_waitcnt lgkmcnt(3)
    v_exp_f32 v101, v69
    v_exp_f32 v102, v70
    v_exp_f32 v103, v71
    v_max3_f32 v23, v23, v30, v31
    v_mov_b32 v134, v24
    v_mov_b32 v135, v24
    v_mad_u32_u16 v24, v24, s42, v2
    v_mad_u32_u16 v27, v27, s42, v133
    v_pk_fma_f32 v[114:115], v[34:35], v[28:29], v[114:115]
    v_pk_add_f32 v[32:33], v[88:89], 1.0 op_sel_hi:[1,0]
    v_pk_fma_f32 v[28:29], v[56:57], v[90:91], v[56:57]
    v_pk_fma_f32 v[30:31], v[32:33], v[90:91], v[32:33]
    v_pk_fma_f32 v[28:29], v[58:59], v[32:33], v[28:29]
    v_pk_fma_f32 v[28:29], v[28:29], v[92:93], v[28:29]
    v_pk_fma_f32 v[32:33], v[30:31], v[92:93], v[30:31]
    v_pk_fma_f32 v[28:29], v[60:61], v[30:31], v[28:29]
    v_pk_fma_f32 v[28:29], v[28:29], v[94:95], v[28:29]
    v_pk_fma_f32 v[30:31], v[32:33], v[94:95], v[32:33]
    v_pk_fma_f32 v[28:29], v[62:63], v[32:33], v[28:29]
    v_pk_fma_f32 v[28:29], v[28:29], v[96:97], v[28:29]
    v_pk_fma_f32 v[32:33], v[30:31], v[96:97], v[30:31]
    v_pk_fma_f32 v[28:29], v[64:65], v[30:31], v[28:29]
    v_pk_fma_f32 v[28:29], v[28:29], v[98:99], v[28:29]
    v_pk_fma_f32 v[30:31], v[32:33], v[98:99], v[32:33]
    v_pk_fma_f32 v[28:29], v[66:67], v[32:33], v[28:29]
    v_pk_fma_f32 v[28:29], v[28:29], v[100:101], v[28:29]
    v_pk_fma_f32 v[32:33], v[30:31], v[100:101], v[30:31]
    v_pk_fma_f32 v[28:29], v[68:69], v[30:31], v[28:29]
    v_pk_fma_f32 v[28:29], v[28:29], v[102:103], v[28:29]
    v_pk_fma_f32 v[30:31], v[32:33], v[102:103], v[32:33]
    v_pk_fma_f32 v[28:29], v[70:71], v[32:33], v[28:29]
    v_mfma_f32_32x32x16_bf16 v[56:71], v[36:39], a[0:3], 0
    s_waitcnt lgkmcnt(0)
    v_rcp_f32 v34, v30
    v_rcp_f32 v35, v31
    v_exp_f32 v88, v72
    v_mfma_f32_32x32x16_bf16 v[56:71], v[40:43], a[16:19], v[56:71]
    buffer_load_dwordx4 v24, s[20:23], 0 offen offset:0 lds
    v_exp_f32 v89, v73
    v_exp_f32 v90, v74
    v_exp_f32_e64 v91, v75
    v_mfma_f32_32x32x16_bf16 v[56:71], v[44:47], a[32:35], v[56:71]
    buffer_load_dwordx4 v25, s[20:23], 0 offen offset:1024 lds
    v_exp_f32 v92, v76
    v_exp_f32 v93, v77
    v_exp_f32_e64 v94, v78
    v_mfma_f32_32x32x16_bf16 v[56:71], v[48:51], a[48:51], v[56:71]
    buffer_load_dwordx4 v26, s[20:23], 0 offen offset:2048 lds
    v_exp_f32 v95, v79
    v_exp_f32 v96, v80
    v_exp_f32_e64 v97, v81
    v_mfma_f32_32x32x16_bf16 v[56:71], v[52:55], a[64:67], v[56:71]
    buffer_load_dwordx4 v27, s[20:23], 0 offen offset:3072 lds
    v_exp_f32 v98, v82
    v_exp_f32 v99, v83
    v_exp_f32_e64 v100, v84
    v_mfma_f32_32x32x8_bf16 v[56:71], v[14:15], v[104:105], v[56:71]
    s_mov_b32 m0, s41
    s_sub_u32 s35, s35, 1
    v_exp_f32 v101, v85
    v_exp_f32 v102, v86
    v_exp_f32_e64 v103, v87
    v_max3_f32 v23, v23, v30, v31
    v_lshl_add_u32 v22, v22, 5, v4
    v_pk_fma_f32 v[116:117], v[34:35], v[28:29], v[116:117]
    v_pk_add_f32 v[32:33], v[88:89], 1.0 op_sel_hi:[1,0]
    v_pk_fma_f32 v[28:29], v[72:73], v[90:91], v[72:73]
    v_pk_fma_f32 v[30:31], v[32:33], v[90:91], v[32:33]
    v_pk_fma_f32 v[28:29], v[74:75], v[32:33], v[28:29]
    v_pk_fma_f32 v[28:29], v[28:29], v[92:93], v[28:29]
    v_pk_fma_f32 v[32:33], v[30:31], v[92:93], v[30:31]
    v_pk_fma_f32 v[28:29], v[76:77], v[30:31], v[28:29]
    v_pk_fma_f32 v[28:29], v[28:29], v[94:95], v[28:29]
    v_pk_fma_f32 v[30:31], v[32:33], v[94:95], v[32:33]
    v_pk_fma_f32 v[28:29], v[78:79], v[32:33], v[28:29]
    v_pk_fma_f32 v[28:29], v[28:29], v[96:97], v[28:29]
    v_pk_fma_f32 v[32:33], v[30:31], v[96:97], v[30:31]
    v_pk_fma_f32 v[28:29], v[80:81], v[30:31], v[28:29]
    v_pk_fma_f32 v[28:29], v[28:29], v[98:99], v[28:29]
    v_pk_fma_f32 v[30:31], v[32:33], v[98:99], v[32:33]
    v_pk_fma_f32 v[28:29], v[82:83], v[32:33], v[28:29]
    v_pk_fma_f32 v[28:29], v[28:29], v[100:101], v[28:29]
    v_pk_fma_f32 v[32:33], v[30:31], v[100:101], v[30:31]
    v_pk_fma_f32 v[28:29], v[84:85], v[30:31], v[28:29]
    v_pk_fma_f32 v[28:29], v[28:29], v[102:103], v[28:29]
    v_pk_fma_f32 v[30:31], v[32:33], v[102:103], v[32:33]
    v_pk_fma_f32 v[28:29], v[86:87], v[32:33], v[28:29]
    s_cbranch_scc1 K2_drainF
    v_mfma_f32_32x32x16_bf16 v[72:87], v[36:39], a[4:7], 0
    buffer_load_dwordx4 v22, s[8:11], 0 offen  lds
    v_rcp_f32 v34, v30
    v_rcp_f32 v35, v31
    v_exp_f32 v88, v56
    v_mfma_f32_32x32x16_bf16 v[72:87], v[40:43], a[20:23], v[72:87]
    ds_read_b128 v[24:27], v11 offset:128
    v_exp_f32 v89, v57
    v_exp_f32 v90, v58
    v_exp_f32_e64 v91, v59
    v_mfma_f32_32x32x16_bf16 v[72:87], v[44:47], a[36:39], v[72:87]
    ds_read_b32 v22, v12 offset:16512
    v_exp_f32 v92, v60
    v_exp_f32 v93, v61
    v_exp_f32_e64 v94, v62
    v_mfma_f32_32x32x16_bf16 v[72:87], v[48:51], a[52:55], v[72:87]
    s_mov_b32 m0, s36
    v_exp_f32 v95, v63
    v_exp_f32 v96, v64
    v_exp_f32 v97, v65
    v_mfma_f32_32x32x16_bf16 v[72:87], v[52:55], a[68:71], v[72:87]
    v_exp_f32 v98, v66
    v_exp_f32 v99, v67
    v_exp_f32_e64 v100, v68
    v_mfma_f32_32x32x8_bf16 v[72:87], v[14:15], v[106:107], v[72:87]
    s_waitcnt lgkmcnt(0)
    v_exp_f32 v101, v69
    v_exp_f32 v102, v70
    v_exp_f32 v103, v71
    v_max3_f32 v23, v23, v30, v31
    v_permlane16_swap_b32_e64 v18, v19
    v_mad_u32_u16 v25, v25, s42, v3
    v_mad_u32_u16 v26, v26, s42, v132
    v_pk_fma_f32 v[118:119], v[34:35], v[28:29], v[118:119]
    v_pk_add_f32 v[32:33], v[88:89], 1.0 op_sel_hi:[1,0]
    v_pk_fma_f32 v[28:29], v[56:57], v[90:91], v[56:57]
    v_pk_fma_f32 v[30:31], v[32:33], v[90:91], v[32:33]
    v_pk_fma_f32 v[28:29], v[58:59], v[32:33], v[28:29]
    v_pk_fma_f32 v[28:29], v[28:29], v[92:93], v[28:29]
    v_pk_fma_f32 v[32:33], v[30:31], v[92:93], v[30:31]
    v_pk_fma_f32 v[28:29], v[60:61], v[30:31], v[28:29]
    v_pk_fma_f32 v[28:29], v[28:29], v[94:95], v[28:29]
    v_pk_fma_f32 v[30:31], v[32:33], v[94:95], v[32:33]
    v_pk_fma_f32 v[28:29], v[62:63], v[32:33], v[28:29]
    v_pk_fma_f32 v[28:29], v[28:29], v[96:97], v[28:29]
    v_pk_fma_f32 v[32:33], v[30:31], v[96:97], v[30:31]
    v_pk_fma_f32 v[28:29], v[64:65], v[30:31], v[28:29]
    v_pk_fma_f32 v[28:29], v[28:29], v[98:99], v[28:29]
    v_pk_fma_f32 v[30:31], v[32:33], v[98:99], v[32:33]
    v_pk_fma_f32 v[28:29], v[66:67], v[32:33], v[28:29]
    v_pk_fma_f32 v[28:29], v[28:29], v[100:101], v[28:29]
    v_pk_fma_f32 v[32:33], v[30:31], v[100:101], v[30:31]
    v_pk_fma_f32 v[28:29], v[68:69], v[30:31], v[28:29]
    v_pk_fma_f32 v[28:29], v[28:29], v[102:103], v[28:29]
    v_pk_fma_f32 v[30:31], v[32:33], v[102:103], v[32:33]
    v_pk_fma_f32 v[28:29], v[70:71], v[32:33], v[28:29]
    v_mfma_f32_32x32x16_bf16 v[56:71], v[36:39], a[8:11], 0
    s_cbranch_vccz K2_flF10
    s_mov_b64 exec, vcc
    v_mad_u32_u16 v128, v20, s99, v5 op_sel:[1,0,0,0]
    v_cvt_f64_f32 v[120:121], v112
    v_cvt_f64_f32 v[122:123], v114
    v_cvt_f64_f32 v[124:125], v116
    v_cvt_f64_f32 v[126:127], v118
    ds_add_f64 v16, v[120:121] offset:22784
    ds_add_f64 v16, v[122:123] offset:23040
    ds_add_f64 v16, v[124:125] offset:23296
    ds_add_f64 v16, v[126:127] offset:23552
    ds_read_b32 v110, v128 offset:1408
    v_mov_b32 v112, 0
    v_mov_b32 v114, 0
    v_mov_b32 v116, 0
    v_mov_b32 v118, 0
    v_mad_u32_u16 v16, v20, s100, v13 op_sel:[1,0,0,0]
    s_mov_b64 exec, -1
K2_flF10:
    v_rcp_f32 v34, v30
    v_rcp_f32 v35, v31
    v_exp_f32 v88, v72
    v_mfma_f32_32x32x16_bf16 v[56:71], v[40:43], a[24:27], v[56:71]
    s_cmp_eq_u64 s[48:49], 0
    s_cbranch_scc1 K2_flF11
    s_mov_b64 exec, s[48:49]
    v_mad_u32_u16 v129, v21, s99, v5 op_sel:[1,0,0,0]
    v_cvt_f64_f32 v[120:121], v113
    v_cvt_f64_f32 v[122:123], v115
    v_cvt_f64_f32 v[124:125], v117
    v_cvt_f64_f32_e64 v[126:127], v119
    ds_add_f64 v17, v[120:121] offset:22784
    ds_add_f64 v17, v[122:123] offset:23040
    ds_add_f64 v17, v[124:125] offset:23296
    ds_add_f64 v17, v[126:127] offset:23552
    ds_read_b32 v111, v129 offset:1408
    v_mov_b32 v113, 0
    v_mov_b32 v115, 0
    v_mov_b32 v117, 0
    v_mov_b32 v119, 0
    v_mad_u32_u16 v17, v21, s100, v13 op_sel:[1,0,0,0]
    s_mov_b64 exec, -1
K2_flF11:
    v_exp_f32 v89, v73
    v_exp_f32 v90, v74
    v_exp_f32 v91, v75
    v_mfma_f32_32x32x16_bf16 v[56:71], v[44:47], a[40:43], v[56:71]
    s_cmp_gt_u32 s35, 2
    v_exp_f32 v92, v76
    v_exp_f32 v93, v77
    v_exp_f32 v94, v78
    v_mfma_f32_32x32x16_bf16 v[56:71], v[48:51], a[56:59], v[56:71]
    s_cselect_b32 s22, 1283072, 0
    v_exp_f32 v95, v79
    v_exp_f32 v96, v80
    v_exp_f32_e64 v97, v81
    v_mfma_f32_32x32x16_bf16 v[56:71], v[52:55], a[72:75], v[56:71]
    s_cselect_b32 s10, 20480000, 0
    v_exp_f32 v98, v82
    v_exp_f32 v99, v83
    v_exp_f32_e64 v100, v84
    v_mfma_f32_32x32x8_bf16 v[56:71], v[14:15], v[108:109], v[56:71]
    s_waitcnt vmcnt(5) lgkmcnt(0)
    v_exp_f32 v101, v85
    v_exp_f32 v102, v86
    v_exp_f32 v103, v87
    v_max3_f32 v23, v23, v30, v31
    v_cmp_ne_u32_sdwa vcc, v18, v20 src0_sel:WORD_1 src1_sel:WORD_1
    v_cmp_ne_u32_sdwa s[48:49], v19, v21 src0_sel:WORD_1 src1_sel:WORD_1
    v_mov_b64_e64 v[20:21], v[134:135]
    v_pk_fma_f32 v[112:113], v[34:35], v[28:29], v[112:113]
    v_pk_add_f32 v[32:33], v[88:89], 1.0 op_sel_hi:[1,0]
    v_pk_fma_f32 v[28:29], v[72:73], v[90:91], v[72:73]
    v_pk_fma_f32 v[30:31], v[32:33], v[90:91], v[32:33]
    v_pk_fma_f32 v[28:29], v[74:75], v[32:33], v[28:29]
    v_pk_fma_f32 v[28:29], v[28:29], v[92:93], v[28:29]
    v_pk_fma_f32 v[32:33], v[30:31], v[92:93], v[30:31]
    v_pk_fma_f32 v[28:29], v[76:77], v[30:31], v[28:29]
    v_pk_fma_f32 v[28:29], v[28:29], v[94:95], v[28:29]
    v_pk_fma_f32 v[30:31], v[32:33], v[94:95], v[32:33]
    v_pk_fma_f32 v[28:29], v[78:79], v[32:33], v[28:29]
    v_pk_fma_f32 v[28:29], v[28:29], v[96:97], v[28:29]
    v_pk_fma_f32 v[32:33], v[30:31], v[96:97], v[30:31]
    v_pk_fma_f32 v[28:29], v[80:81], v[30:31], v[28:29]
    v_pk_fma_f32 v[28:29], v[28:29], v[98:99], v[28:29]
    v_pk_fma_f32 v[30:31], v[32:33], v[98:99], v[32:33]
    v_pk_fma_f32 v[28:29], v[82:83], v[32:33], v[28:29]
    v_pk_fma_f32 v[28:29], v[28:29], v[100:101], v[28:29]
    v_pk_fma_f32 v[32:33], v[30:31], v[100:101], v[30:31]
    v_pk_fma_f32 v[28:29], v[84:85], v[30:31], v[28:29]
    v_pk_fma_f32 v[28:29], v[28:29], v[102:103], v[28:29]
    v_pk_fma_f32 v[30:31], v[32:33], v[102:103], v[32:33]
    v_pk_fma_f32 v[28:29], v[86:87], v[32:33], v[28:29]
    v_mfma_f32_32x32x16_bf16 v[72:87], v[36:39], a[12:15], 0
    s_cbranch_vccz K2_qlF10
    s_mov_b64 exec, vcc
    v_mad_u32_u16 v128, v18, s99, v5 op_sel:[1,0,0,0]
    ds_read_b32 v104, v128 offset:1024
    ds_read_b32 v106, v128 offset:1152
    ds_read_b32 v108, v128 offset:1280
    s_mov_b64 exec, -1
K2_qlF10:
    ds_read_b128 v[36:39], v6 offset:0
    v_rcp_f32 v34, v30
    v_rcp_f32 v35, v31
    v_exp_f32 v88, v56
    v_mfma_f32_32x32x16_bf16 v[72:87], v[40:43], a[28:31], v[72:87]
    s_cmp_eq_u64 s[48:49], 0
    s_cbranch_scc1 K2_qlF11
    s_mov_b64 exec, s[48:49]
    v_mad_u32_u16 v129, v19, s99, v5 op_sel:[1,0,0,0]
    ds_read_b32 v105, v129 offset:1024
    ds_read_b32 v107, v129 offset:1152
    ds_read_b32 v109, v129 offset:1280
    s_mov_b64 exec, -1
K2_qlF11:
    ds_read_b128 v[40:43], v7 offset:0
    v_exp_f32 v89, v57
    v_exp_f32 v90, v58
    v_exp_f32_e64 v91, v59
    v_mfma_f32_32x32x16_bf16 v[72:87], v[44:47], a[44:47], v[72:87]
    ds_read_b128 v[44:47], v8 offset:0
    v_exp_f32 v92, v60
    v_exp_f32 v93, v61
    v_exp_f32_e64 v94, v62
    v_mfma_f32_32x32x16_bf16 v[72:87], v[48:51], a[60:63], v[72:87]
    ds_read_b128 v[48:51], v9 offset:0
    v_exp_f32 v95, v63
    v_exp_f32 v96, v64
    v_exp_f32_e64 v97, v65
    v_mfma_f32_32x32x16_bf16 v[72:87], v[52:55], a[76:79], v[72:87]
    ds_read_b128 v[52:55], v10 offset:0
    v_exp_f32 v98, v66
    v_exp_f32 v99, v67
    v_exp_f32_e64 v100, v68
    v_mfma_f32_32x32x8_bf16 v[72:87], v[14:15], v[110:111], v[72:87]
    s_waitcnt lgkmcnt(3)
    v_exp_f32 v101, v69
    v_exp_f32 v102, v70
    v_exp_f32 v103, v71
    v_max3_f32 v23, v23, v30, v31
    v_mov_b32 v134, v24
    v_mov_b32 v135, v24
    v_mad_u32_u16 v24, v24, s42, v2
    v_mad_u32_u16 v27, v27, s42, v133
    v_pk_fma_f32 v[114:115], v[34:35], v[28:29], v[114:115]
    v_pk_add_f32 v[32:33], v[88:89], 1.0 op_sel_hi:[1,0]
    v_pk_fma_f32 v[28:29], v[56:57], v[90:91], v[56:57]
    v_pk_fma_f32 v[30:31], v[32:33], v[90:91], v[32:33]
    v_pk_fma_f32 v[28:29], v[58:59], v[32:33], v[28:29]
    v_pk_fma_f32 v[28:29], v[28:29], v[92:93], v[28:29]
    v_pk_fma_f32 v[32:33], v[30:31], v[92:93], v[30:31]
    v_pk_fma_f32 v[28:29], v[60:61], v[30:31], v[28:29]
    v_pk_fma_f32 v[28:29], v[28:29], v[94:95], v[28:29]
    v_pk_fma_f32 v[30:31], v[32:33], v[94:95], v[32:33]
    v_pk_fma_f32 v[28:29], v[62:63], v[32:33], v[28:29]
    v_pk_fma_f32 v[28:29], v[28:29], v[96:97], v[28:29]
    v_pk_fma_f32 v[32:33], v[30:31], v[96:97], v[30:31]
    v_pk_fma_f32 v[28:29], v[64:65], v[30:31], v[28:29]
    v_pk_fma_f32 v[28:29], v[28:29], v[98:99], v[28:29]
    v_pk_fma_f32 v[30:31], v[32:33], v[98:99], v[32:33]
    v_pk_fma_f32 v[28:29], v[66:67], v[32:33], v[28:29]
    v_pk_fma_f32 v[28:29], v[28:29], v[100:101], v[28:29]
    v_pk_fma_f32 v[32:33], v[30:31], v[100:101], v[30:31]
    v_pk_fma_f32 v[28:29], v[68:69], v[30:31], v[28:29]
    v_pk_fma_f32 v[28:29], v[28:29], v[102:103], v[28:29]
    v_pk_fma_f32 v[30:31], v[32:33], v[102:103], v[32:33]
    v_pk_fma_f32 v[28:29], v[70:71], v[32:33], v[28:29]
    v_mfma_f32_32x32x16_bf16 v[56:71], v[36:39], a[0:3], 0
    s_waitcnt lgkmcnt(0)
    v_rcp_f32 v34, v30
    v_rcp_f32 v35, v31
    v_exp_f32 v88, v72
    v_mfma_f32_32x32x16_bf16 v[56:71], v[40:43], a[16:19], v[56:71]
    buffer_load_dwordx4 v24, s[20:23], 0 offen offset:0 lds
    v_exp_f32 v89, v73
    v_exp_f32 v90, v74
    v_exp_f32_e64 v91, v75
    v_mfma_f32_32x32x16_bf16 v[56:71], v[44:47], a[32:35], v[56:71]
    buffer_load_dwordx4 v25, s[20:23], 0 offen offset:1024 lds
    v_exp_f32 v92, v76
    v_exp_f32 v93, v77
    v_exp_f32_e64 v94, v78
    v_mfma_f32_32x32x16_bf16 v[56:71], v[48:51], a[48:51], v[56:71]
    buffer_load_dwordx4 v26, s[20:23], 0 offen offset:2048 lds
    v_exp_f32 v95, v79
    v_exp_f32 v96, v80
    v_exp_f32_e64 v97, v81
    v_mfma_f32_32x32x16_bf16 v[56:71], v[52:55], a[64:67], v[56:71]
    buffer_load_dwordx4 v27, s[20:23], 0 offen offset:3072 lds
    v_exp_f32 v98, v82
    v_exp_f32 v99, v83
    v_exp_f32_e64 v100, v84
    v_mfma_f32_32x32x8_bf16 v[56:71], v[14:15], v[104:105], v[56:71]
    s_mov_b32 m0, s40
    s_sub_u32 s35, s35, 1
    v_exp_f32 v101, v85
    v_exp_f32 v102, v86
    v_exp_f32_e64 v103, v87
    v_max3_f32 v23, v23, v30, v31
    v_lshl_add_u32 v22, v22, 5, v4
    v_add_u32 v11, 64, v11
    v_add_u32 v12, 64, v12
    v_pk_fma_f32 v[116:117], v[34:35], v[28:29], v[116:117]
    v_pk_add_f32 v[32:33], v[88:89], 1.0 op_sel_hi:[1,0]
    v_pk_fma_f32 v[28:29], v[72:73], v[90:91], v[72:73]
    v_pk_fma_f32 v[30:31], v[32:33], v[90:91], v[32:33]
    v_pk_fma_f32 v[28:29], v[74:75], v[32:33], v[28:29]
    v_pk_fma_f32 v[28:29], v[28:29], v[92:93], v[28:29]
    v_pk_fma_f32 v[32:33], v[30:31], v[92:93], v[30:31]
    v_pk_fma_f32 v[28:29], v[76:77], v[30:31], v[28:29]
    v_pk_fma_f32 v[28:29], v[28:29], v[94:95], v[28:29]
    v_pk_fma_f32 v[30:31], v[32:33], v[94:95], v[32:33]
    v_pk_fma_f32 v[28:29], v[78:79], v[32:33], v[28:29]
    v_pk_fma_f32 v[28:29], v[28:29], v[96:97], v[28:29]
    v_pk_fma_f32 v[32:33], v[30:31], v[96:97], v[30:31]
    v_pk_fma_f32 v[28:29], v[80:81], v[30:31], v[28:29]
    v_pk_fma_f32 v[28:29], v[28:29], v[98:99], v[28:29]
    v_pk_fma_f32 v[30:31], v[32:33], v[98:99], v[32:33]
    v_pk_fma_f32 v[28:29], v[82:83], v[32:33], v[28:29]
    v_pk_fma_f32 v[28:29], v[28:29], v[100:101], v[28:29]
    v_pk_fma_f32 v[32:33], v[30:31], v[100:101], v[30:31]
    v_pk_fma_f32 v[28:29], v[84:85], v[30:31], v[28:29]
    v_pk_fma_f32 v[28:29], v[28:29], v[102:103], v[28:29]
    v_pk_fma_f32 v[30:31], v[32:33], v[102:103], v[32:33]
    v_pk_fma_f32 v[28:29], v[86:87], v[32:33], v[28:29]
    s_cbranch_scc0 K2_loopF
K2_drainF:
    v_rcp_f32 v34, v30
    v_rcp_f32 v35, v31
    v_max3_f32 v23, v23, v30, v31
    v_pk_fma_f32 v[118:119], v[34:35], v[28:29], v[118:119]
    v_cvt_f64_f32 v[120:121], v112
    v_cvt_f64_f32 v[122:123], v114
    v_cvt_f64_f32 v[124:125], v116
    v_cvt_f64_f32 v[126:127], v118
    ds_add_f64 v16, v[120:121] offset:22784
    ds_add_f64 v16, v[122:123] offset:23040
    ds_add_f64 v16, v[124:125] offset:23296
    ds_add_f64 v16, v[126:127] offset:23552
    v_cvt_f64_f32 v[88:89], v113
    v_cvt_f64_f32 v[90:91], v115
    v_cvt_f64_f32 v[92:93], v117
    v_cvt_f64_f32 v[94:95], v119
    ds_add_f64 v17, v[88:89] offset:22784
    ds_add_f64 v17, v[90:91] offset:23040
    ds_add_f64 v17, v[92:93] offset:23296
    ds_add_f64 v17, v[94:95] offset:23552
K2_loop_done:
    s_mov_b32 s80, 0x7b800000
    v_cmp_le_f32 vcc, s80, v23
    v_mov_b32 v128, 768
    v_mov_b32 v129, 1
    s_and_saveexec_b64 s[88:89], vcc
    s_cbranch_execz K2_noflag
    ds_write_b32 v128, v129
K2_noflag:
    s_mov_b64 exec, -1
    v_and_b32 v130, 15, v1
    v_lshrrev_b32 v131, 4, v1
    s_and_b32 s81, s3, 1
    s_lshr_b32 s82, s3, 1
    s_lshl_b32 s83, s81, 6
    v_lshlrev_b32 v132, 4, v131
    buffer_load_dwordx4 v[20:23], v132, s[24:27], s83 offen
    s_add_u32 s83, s83, 147456
    v_bfe_u32 v133, v1, 2, 2
    v_lshl_add_u32 v133, v131, 5, v133
    v_and_b32 v134, 3, v1
    v_lshlrev_b32 v134, 4, v134
    v_lshl_add_u32 v133, v133, 7, v134
    v_add_u32 v133, s83, v133
    ds_read_b64_tr_b16 v[56:57], v133 offset:0
    ds_read_b64_tr_b16 v[58:59], v133 offset:512
    ds_read_b64_tr_b16 v[60:61], v133 offset:1024
    ds_read_b64_tr_b16 v[62:63], v133 offset:1536
    ds_read_b64_tr_b16 v[64:65], v133 offset:2048
    ds_read_b64_tr_b16 v[66:67], v133 offset:2560
    ds_read_b64_tr_b16 v[68:69], v133 offset:3072
    ds_read_b64_tr_b16 v[70:71], v133 offset:3584
    ds_read_b64_tr_b16 v[72:73], v133 offset:8
    ds_read_b64_tr_b16 v[74:75], v133 offset:520
    ds_read_b64_tr_b16 v[76:77], v133 offset:1032
    ds_read_b64_tr_b16 v[78:79], v133 offset:1544
    ds_read_b64_tr_b16 v[80:81], v133 offset:2056
    ds_read_b64_tr_b16 v[82:83], v133 offset:2568
    ds_read_b64_tr_b16 v[84:85], v133 offset:3080
    ds_read_b64_tr_b16 v[86:87], v133 offset:3592
    s_waitcnt vmcnt(0) lgkmcnt(0)
    s_barrier
    s_cmp_eq_u32 s31, 0
    s_cbranch_scc1 K2_epi
    ds_read_b32 v129, v128 offset:4
    s_add_u32 s33, s33, 1
    s_mov_b32 s34, 0
    s_waitcnt lgkmcnt(0)
    v_readfirstlane_b32 s84, v129
    s_cmp_eq_u32 s31, 1
    s_cbranch_scc1 K2_adv1
    s_cmp_lt_u32 s33, 256
    s_cbranch_scc1 K2_rebatch
    s_branch K2_epi
K2_adv1:
    s_cmp_lt_u32 s33, 4
    s_cbranch_scc1 K2_rebatch
    s_mov_b32 s33, 0
    s_add_u32 s32, s32, 40
    s_cmp_lt_u32 s32, s84
    s_cbranch_scc1 K2_rebatch
K2_epi:
    s_cmp_ge_u32 s3, 6
    s_cbranch_scc1 K2_epi_done
    s_lshl_b32 s84, s82, 4
    v_add_u32 v130, s84, v130
    v_lshlrev_b32 v133, 8, v131
    v_mad_u32_u24 v133, v130, s100, v133
    v_lshlrev_b32 v132, 2, v130
    ds_read_b32 v129, v132 offset:256
    ds_read_b128 v[24:27], v133 offset:22784
    ds_read_b128 v[28:31], v133 offset:22800
    ds_read_b128 v[32:35], v133 offset:22816
    ds_read_b128 v[36:39], v133 offset:22832
    ds_read_b128 v[40:43], v133 offset:22848
    ds_read_b128 v[44:47], v133 offset:22864
    ds_read_b128 v[48:51], v133 offset:22880
    ds_read_b128 v[52:55], v133 offset:22896
    ds_read_b128 v[88:91], v133 offset:22912
    ds_read_b128 v[92:95], v133 offset:22928
    ds_read_b128 v[96:99], v133 offset:22944
    ds_read_b128 v[100:103], v133 offset:22960
    s_waitcnt lgkmcnt(8)
    ds_read_b128 v[104:107], v133 offset:22976
    ds_read_b128 v[108:111], v133 offset:22992
    ds_read_b128 v[112:115], v133 offset:23008
    ds_read_b128 v[116:119], v133 offset:23024
    v_lshlrev_b32 v132, 4, v131
    v_lshl_add_u32 v132, v130, 7, v132
    s_lshl_b32 s85, s29, 7
    s_lshl_b32 s86, s81, 6
    s_add_u32 s85, s85, s86
    v_lshlrev_b32 v2, 16, v20
    v_and_b32 v3, 0xffff0000, v20
    v_lshlrev_b32 v4, 16, v21
    v_and_b32 v5, 0xffff0000, v21
    v_lshlrev_b32 v6, 16, v22
    v_and_b32 v7, 0xffff0000, v22
    v_lshlrev_b32 v8, 16, v23
    v_and_b32 v9, 0xffff0000, v23
    s_waitcnt lgkmcnt(12)
    v_cvt_f32_f64 v24, v[24:25]
    v_cvt_f32_f64 v25, v[26:27]
    v_cvt_f32_f64 v26, v[28:29]
    v_cvt_f32_f64 v27, v[30:31]
    v_cvt_f32_f64 v28, v[32:33]
    v_cvt_f32_f64 v29, v[34:35]
    v_cvt_f32_f64 v30, v[36:37]
    v_cvt_f32_f64 v31, v[38:39]
    v_cvt_pk_bf16_f32 v24, v24, v25
    v_cvt_pk_bf16_f32 v25, v26, v27
    v_cvt_pk_bf16_f32 v26, v28, v29
    v_cvt_pk_bf16_f32 v27, v30, v31
    s_waitcnt lgkmcnt(8)
    v_cvt_f32_f64 v40, v[40:41]
    v_cvt_f32_f64 v41, v[42:43]
    v_cvt_f32_f64 v42, v[44:45]
    v_cvt_f32_f64 v43, v[46:47]
    v_cvt_f32_f64 v44, v[48:49]
    v_cvt_f32_f64 v45, v[50:51]
    v_cvt_f32_f64 v46, v[52:53]
    v_cvt_f32_f64 v47, v[54:55]
    v_cvt_pk_bf16_f32 v40, v40, v41
    v_cvt_pk_bf16_f32 v41, v42, v43
    v_cvt_pk_bf16_f32 v42, v44, v45
    v_cvt_pk_bf16_f32 v43, v46, v47
    s_waitcnt lgkmcnt(4)
    v_cvt_f32_f64 v88, v[88:89]
    v_cvt_f32_f64 v89, v[90:91]
    v_cvt_f32_f64 v90, v[92:93]
    v_cvt_f32_f64 v91, v[94:95]
    v_cvt_f32_f64 v92, v[96:97]
    v_cvt_f32_f64 v93, v[98:99]
    v_cvt_f32_f64 v94, v[100:101]
    v_cvt_f32_f64 v95, v[102:103]
    v_cvt_pk_bf16_f32 v88, v88, v89
    v_cvt_pk_bf16_f32 v89, v90, v91
    v_cvt_pk_bf16_f32 v90, v92, v93
    v_cvt_pk_bf16_f32 v91, v94, v95
    s_waitcnt lgkmcnt(0)
    v_cvt_f32_f64 v104, v[104:105]
    v_cvt_f32_f64 v105, v[106:107]
    v_cvt_f32_f64 v106, v[108:109]
    v_cvt_f32_f64 v107, v[110:111]
    v_cvt_f32_f64 v108, v[112:113]
    v_cvt_f32_f64 v109, v[114:115]
    v_cvt_f32_f64 v110, v[116:117]
    v_cvt_f32_f64 v111, v[118:119]
    v_cvt_pk_bf16_f32 v104, v104, v105
    v_cvt_pk_bf16_f32 v105, v106, v107
    v_cvt_pk_bf16_f32 v106, v108, v109
    v_cvt_pk_bf16_f32 v107, v110, v111
    v_cvt_f32_u32 v129, v129
    v_mul_f32 v129, 0.5, v129
    v_mul_f32 v129, 0.5, v129
    v_mfma_f32_16x16x32_bf16 v[12:15], v[56:59], v[24:27], 0
    v_mfma_f32_16x16x32_bf16 v[16:19], v[72:75], v[24:27], 0
    v_mfma_f32_16x16x32_bf16 v[12:15], v[60:63], v[40:43], v[12:15]
    v_mfma_f32_16x16x32_bf16 v[16:19], v[76:79], v[40:43], v[16:19]
    v_mfma_f32_16x16x32_bf16 v[12:15], v[64:67], v[88:91], v[12:15]
    v_mfma_f32_16x16x32_bf16 v[16:19], v[80:83], v[88:91], v[16:19]
    v_mfma_f32_16x16x32_bf16 v[12:15], v[68:71], v[104:107], v[12:15]
    v_mfma_f32_16x16x32_bf16 v[16:19], v[84:87], v[104:107], v[16:19]
    v_mul_f32 v2, v129, v2
    v_mul_f32 v3, v129, v3
    v_mul_f32 v4, v129, v4
    v_mul_f32 v5, v129, v5
    v_mul_f32 v6, v129, v6
    v_mul_f32 v7, v129, v7
    v_mul_f32 v8, v129, v8
    v_mul_f32 v9, v129, v9
    s_mov_b32 s86, 0xbf317218
    v_cmp_gt_u32 vcc, s30, v130
    s_nop 0
    s_and_saveexec_b64 s[88:89], vcc
    s_cbranch_execz K2_epi_done
    v_fma_f32 v2, v12, s86, v2
    v_fma_f32 v3, v13, s86, v3
    v_fma_f32 v4, v14, s86, v4
    v_fma_f32 v5, v15, s86, v5
    v_fma_f32 v6, v16, s86, v6
    v_fma_f32 v7, v17, s86, v7
    v_fma_f32 v8, v18, s86, v8
    v_fma_f32 v9, v19, s86, v9
    v_cvt_pk_bf16_f32 v24, v2, v3
    v_cvt_pk_bf16_f32 v25, v4, v5
    v_cvt_pk_bf16_f32 v26, v6, v7
    v_cvt_pk_bf16_f32 v27, v8, v9
    buffer_store_dwordx4 v[24:27], v132, s[16:19], s85 offen sc1
    v_sub_f32 v2, v2, v2
    v_fma_f32 v2, v3, 0, v2
    v_fma_f32 v2, v4, 0, v2
    v_fma_f32 v2, v5, 0, v2
    v_fma_f32 v2, v6, 0, v2
    v_fma_f32 v2, v7, 0, v2
    v_fma_f32 v2, v8, 0, v2
    v_fma_f32 v2, v9, 0, v2
    v_cmp_u_f32 vcc, v2, v2
    v_mov_b32 v129, 1
    s_and_b64 exec, exec, vcc
    s_cbranch_execz K2_epi_done
    ds_write_b32 v128, v129
K2_epi_done:
    s_mov_b64 exec, -1
    s_cmp_lg_u32 s31, 0
    s_cbranch_scc1 K2_end
    s_waitcnt lgkmcnt(0)
    s_barrier
    ds_read_b32 v129, v128
    s_waitcnt lgkmcnt(0)
    v_readfirstlane_b32 s84, v129
    s_cmp_eq_u32 s84, 0
    s_cbranch_scc1 K2_end
K2_togeneral:
    v_mov_b32 v128, 0
    ds_read_b32 v129, v128 offset:776
    s_waitcnt lgkmcnt(0)
    v_readfirstlane_b32 s31, v129
    s_add_u32 s31, s31, 1
    s_mov_b32 s32, 0
    s_mov_b32 s33, 0
    s_mov_b32 s34, 1
K2_rebatch:
    s_waitcnt vmcnt(0) lgkmcnt(0)
    s_barrier
    s_branch K2_batch
K2_end:
    s_endpgm
F_setup:
    v_bfe_u32 v133, v1, 2, 2
    v_lshl_add_u32 v133, v132, 3, v133
    v_lshlrev_b32 v133, 6, v133
    v_bfe_u32 v135, v1, 4, 1
    v_lshl_add_u32 v133, v135, 5, v133
    v_and_b32 v135, 3, v1
    v_lshl_add_u32 v133, v135, 3, v133
    v_add_u32 v133, s83, v133
    v_bfe_u32 v135, v131, 1, 3
    v_xor_b32 v135, v135, v132
    v_lshlrev_b32 v135, 4, v135
    v_lshl_add_u32 v135, v131, 7, v135
    v_add_u32 v135, 135168, v135
    s_mov_b32 s86, 0xbfb8aa3b
    v_add_u32 v128, s85, v130
    v_lshlrev_b32 v5, 2, v131
    v_lshlrev_b32 v13, 3, v131
    s_add_u32 m0, s83, 4096
    s_add_u32 s84, s82, 16384
    buffer_load_dwordx4 v129, s[20:23], s84 offen lds
    s_add_u32 m0, s83, 5120
    s_add_u32 s84, s82, 20480
    buffer_load_dwordx4 v129, s[20:23], s84 offen lds
    s_add_u32 m0, s83, 6144
    s_add_u32 s84, s82, 24576
    buffer_load_dwordx4 v129, s[20:23], s84 offen lds
    s_add_u32 m0, s83, 7168
    s_add_u32 s84, s82, 28672
    buffer_load_dwordx4 v129, s[20:23], s84 offen lds
    s_mov_b32 s20, s62
    s_and_b32 s21, s63, 0xffff
    s_mov_b32 s22, 256
    s_mov_b32 s23, 0x20000
    v_lshlrev_b32 v129, 1, v131
    buffer_load_ushort v138, v129, s[20:23], s82 offen
    s_waitcnt vmcnt(5)
    s_cmp_lg_u32 s3, 4
    s_cbranch_scc1 F_tagok
    s_movk_i32 s89, 4000
F_tagpoll:
    v_cmp_ne_u32 vcc, 0, v142
    s_cbranch_vccnz F_taggot
    global_load_dwordx2 v[142:143], v140, s[76:77] sc1
    s_sub_u32 s89, s89, 1
    s_waitcnt vmcnt(0)
    s_cbranch_scc0 F_tagpoll
F_taggot:
    v_mov_b32 v141, 0
    ds_write_b64 v141, v[142:143] offset:784
    s_waitcnt lgkmcnt(0)
F_tagok:
    s_barrier
    ds_read_b64_tr_b16 v[88:89], v133 offset:0
    ds_read_b64_tr_b16 v[90:91], v133 offset:256
    ds_read_b64_tr_b16 v[92:93], v133 offset:1024
    ds_read_b64_tr_b16 v[94:95], v133 offset:1280
    ds_read_b64_tr_b16 v[96:97], v133 offset:2048
    ds_read_b64_tr_b16 v[98:99], v133 offset:2304
    ds_read_b64_tr_b16 v[100:101], v133 offset:3072
    ds_read_b64_tr_b16 v[102:103], v133 offset:3328
    ds_read_b64_tr_b16 v[104:105], v133 offset:8192
    ds_read_b64_tr_b16 v[106:107], v133 offset:8448
    s_waitcnt lgkmcnt(8)
    v_lshlrev_b32 v16, 16, v88
    v_and_b32 v17, 0xffff0000, v88
    v_lshlrev_b32 v18, 16, v89
    v_and_b32 v19, 0xffff0000, v89
    v_lshlrev_b32 v20, 16, v90
    v_and_b32 v21, 0xffff0000, v90
    v_lshlrev_b32 v22, 16, v91
    v_and_b32 v23, 0xffff0000, v91
    v_mul_f32 v16, s86, v16
    v_mul_f32 v17, s86, v17
    v_mul_f32 v18, s86, v18
    v_mul_f32 v19, s86, v19
    v_mul_f32 v20, s86, v20
    v_mul_f32 v21, s86, v21
    v_mul_f32 v22, s86, v22
    v_mul_f32 v23, s86, v23
    v_cvt_pk_bf16_f32 v88, v16, v17
    v_cvt_pk_bf16_f32 v89, v18, v19
    v_cvt_pk_bf16_f32 v90, v20, v21
    v_cvt_pk_bf16_f32 v91, v22, v23
    ds_write_b128 v128, v[88:91] offset:22784
    s_waitcnt lgkmcnt(7)
    v_lshlrev_b32 v16, 16, v92
    v_and_b32 v17, 0xffff0000, v92
    v_lshlrev_b32 v18, 16, v93
    v_and_b32 v19, 0xffff0000, v93
    v_lshlrev_b32 v20, 16, v94
    v_and_b32 v21, 0xffff0000, v94
    v_lshlrev_b32 v22, 16, v95
    v_and_b32 v23, 0xffff0000, v95
    v_mul_f32 v16, s86, v16
    v_mul_f32 v17, s86, v17
    v_mul_f32 v18, s86, v18
    v_mul_f32 v19, s86, v19
    v_mul_f32 v20, s86, v20
    v_mul_f32 v21, s86, v21
    v_mul_f32 v22, s86, v22
    v_mul_f32 v23, s86, v23
    v_cvt_pk_bf16_f32 v92, v16, v17
    v_cvt_pk_bf16_f32 v93, v18, v19
    v_cvt_pk_bf16_f32 v94, v20, v21
    v_cvt_pk_bf16_f32 v95, v22, v23
    ds_write_b128 v128, v[92:95] offset:26880
    s_waitcnt lgkmcnt(6)
    v_lshlrev_b32 v16, 16, v96
    v_and_b32 v17, 0xffff0000, v96
    v_lshlrev_b32 v18, 16, v97
    v_and_b32 v19, 0xffff0000, v97
    v_lshlrev_b32 v20, 16, v98
    v_and_b32 v21, 0xffff0000, v98
    v_lshlrev_b32 v22, 16, v99
    v_and_b32 v23, 0xffff0000, v99
    v_mul_f32 v16, s86, v16
    v_mul_f32 v17, s86, v17
    v_mul_f32 v18, s86, v18
    v_mul_f32 v19, s86, v19
    v_mul_f32 v20, s86, v20
    v_mul_f32 v21, s86, v21
    v_mul_f32 v22, s86, v22
    v_mul_f32 v23, s86, v23
    v_cvt_pk_bf16_f32 v96, v16, v17
    v_cvt_pk_bf16_f32 v97, v18, v19
    v_cvt_pk_bf16_f32 v98, v20, v21
    v_cvt_pk_bf16_f32 v99, v22, v23
    ds_write_b128 v128, v[96:99] offset:30976
    s_waitcnt lgkmcnt(5)
    v_lshlrev_b32 v16, 16, v100
    v_and_b32 v17, 0xffff0000, v100
    v_lshlrev_b32 v18, 16, v101
    v_and_b32 v19, 0xffff0000, v101
    v_lshlrev_b32 v20, 16, v102
    v_and_b32 v21, 0xffff0000, v102
    v_lshlrev_b32 v22, 16, v103
    v_and_b32 v23, 0xffff0000, v103
    v_mul_f32 v16, s86, v16
    v_mul_f32 v17, s86, v17
    v_mul_f32 v18, s86, v18
    v_mul_f32 v19, s86, v19
    v_mul_f32 v20, s86, v20
    v_mul_f32 v21, s86, v21
    v_mul_f32 v22, s86, v22
    v_mul_f32 v23, s86, v23
    v_cvt_pk_bf16_f32 v100, v16, v17
    v_cvt_pk_bf16_f32 v101, v18, v19
    v_cvt_pk_bf16_f32 v102, v20, v21
    v_cvt_pk_bf16_f32 v103, v22, v23
    ds_write_b128 v128, v[100:103] offset:35072
    s_waitcnt lgkmcnt(4)
    v_lshlrev_b32 v16, 16, v104
    v_and_b32 v17, 0xffff0000, v104
    v_lshlrev_b32 v18, 16, v105
    v_and_b32 v19, 0xffff0000, v105
    v_lshlrev_b32 v20, 16, v106
    v_and_b32 v21, 0xffff0000, v106
    v_lshlrev_b32 v22, 16, v107
    v_and_b32 v23, 0xffff0000, v107
    v_mul_f32 v16, s86, v16
    v_mul_f32 v17, s86, v17
    v_mul_f32 v18, s86, v18
    v_mul_f32 v19, s86, v19
    v_mul_f32 v20, s86, v20
    v_mul_f32 v21, s86, v21
    v_mul_f32 v22, s86, v22
    v_mul_f32 v23, s86, v23
    v_cvt_pk_bf16_f32 v104, v16, v17
    v_cvt_pk_bf16_f32 v105, v18, v19
    v_cvt_pk_bf16_f32 v106, v20, v21
    v_cvt_pk_bf16_f32 v107, v22, v23
    ds_write_b128 v128, v[104:107] offset:39168
    s_waitcnt vmcnt(0)
    s_mov_b32 s20, s64
    s_and_b32 s21, s65, 0xffff
    s_mov_b32 s22, 16384
    s_mov_b32 s23, 0x20000
    s_lshl_b32 s82, s56, 12
    s_add_u32 m0, s82, 147456
    s_add_u32 s84, s82, 0
    buffer_load_dwordx4 v130, s[20:23], s84 offen lds
    s_add_u32 m0, s82, 148480
    s_add_u32 s84, s82, 1024
    buffer_load_dwordx4 v130, s[20:23], s84 offen lds
    s_add_u32 m0, s82, 149504
    s_add_u32 s84, s82, 2048
    buffer_load_dwordx4 v130, s[20:23], s84 offen lds
    s_add_u32 m0, s82, 150528
    s_add_u32 s84, s82, 3072
    buffer_load_dwordx4 v130, s[20:23], s84 offen lds
    ds_read_b64_tr_b16 v[68:69], v133 offset:4096
    ds_read_b64_tr_b16 v[70:71], v133 offset:4352
    ds_read_b64_tr_b16 v[72:73], v133 offset:5120
    ds_read_b64_tr_b16 v[74:75], v133 offset:5376
    ds_read_b64_tr_b16 v[76:77], v133 offset:6144
    ds_read_b64_tr_b16 v[78:79], v133 offset:6400
    ds_read_b64_tr_b16 v[80:81], v133 offset:7168
    ds_read_b64_tr_b16 v[82:83], v133 offset:7424
    v_xor_b32 v128, 0, v135
    ds_read_b128 v[36:39], v128
    ds_read_b128 v[52:55], v128 offset:4096
    v_xor_b32 v128, 32, v135
    ds_read_b128 v[40:43], v128
    ds_read_b128 v[56:59], v128 offset:4096
    v_xor_b32 v128, 64, v135
    ds_read_b128 v[44:47], v128
    ds_read_b128 v[60:63], v128 offset:4096
    v_xor_b32 v128, 96, v135
    ds_read_b128 v[48:51], v128
    ds_read_b128 v[64:67], v128 offset:4096
    s_lshl_b32 s87, s56, 7
    s_movk_i32 s88, 2112
    v_mad_u32_u24 v133, v132, s88, v5
    v_add_u32 v133, s87, v133
    v_lshlrev_b32 v138, 16, v138
    v_mul_f32 v138, s86, v138
    s_waitcnt lgkmcnt(0)
    v_mfma_f32_32x32x16_bf16 v[88:103], v[36:39], v[68:71], 0
    v_mfma_f32_32x32x16_bf16 v[88:103], v[40:43], v[72:75], v[88:103]
    v_mfma_f32_32x32x16_bf16 v[88:103], v[44:47], v[76:79], v[88:103]
    v_mfma_f32_32x32x16_bf16 v[88:103], v[48:51], v[80:83], v[88:103]
    v_mfma_f32_32x32x16_bf16 v[112:127], v[52:55], v[68:71], 0
    v_mfma_f32_32x32x16_bf16 v[112:127], v[56:59], v[72:75], v[112:127]
    v_mfma_f32_32x32x16_bf16 v[112:127], v[60:63], v[76:79], v[112:127]
    v_mfma_f32_32x32x16_bf16 v[112:127], v[64:67], v[80:83], v[112:127]
    s_nop 7
    v_fma_f32 v88, v88, s86, v138
    v_fma_f32 v89, v89, s86, v138
    v_fma_f32 v90, v90, s86, v138
    v_fma_f32 v91, v91, s86, v138
    v_fma_f32 v92, v92, s86, v138
    v_fma_f32 v93, v93, s86, v138
    v_fma_f32 v94, v94, s86, v138
    v_fma_f32 v95, v95, s86, v138
    v_fma_f32 v96, v96, s86, v138
    v_fma_f32 v97, v97, s86, v138
    v_fma_f32 v98, v98, s86, v138
    v_fma_f32 v99, v99, s86, v138
    v_fma_f32 v100, v100, s86, v138
    v_fma_f32 v101, v101, s86, v138
    v_fma_f32 v102, v102, s86, v138
    v_fma_f32 v103, v103, s86, v138
    v_fma_f32 v112, v112, s86, v138
    v_fma_f32 v113, v113, s86, v138
    v_fma_f32 v114, v114, s86, v138
    v_fma_f32 v115, v115, s86, v138
    v_cvt_pk_bf16_f32 v36, v88, v88
    v_cvt_pk_bf16_f32 v37, v89, v89
    v_cvt_pk_bf16_f32 v38, v90, v90
    v_cvt_pk_bf16_f32 v39, v91, v91
    v_cvt_pk_bf16_f32 v40, v92, v92
    v_cvt_pk_bf16_f32 v41, v93, v93
    v_cvt_pk_bf16_f32 v42, v94, v94
    v_cvt_pk_bf16_f32 v43, v95, v95
    v_cvt_pk_bf16_f32 v44, v96, v96
    v_cvt_pk_bf16_f32 v45, v97, v97
    v_cvt_pk_bf16_f32 v46, v98, v98
    v_cvt_pk_bf16_f32 v47, v99, v99
    v_cvt_pk_bf16_f32 v48, v100, v100
    v_cvt_pk_bf16_f32 v49, v101, v101
    v_cvt_pk_bf16_f32 v50, v102, v102
    v_cvt_pk_bf16_f32 v51, v103, v103
    v_cvt_pk_bf16_f32 v52, v112, v112
    v_cvt_pk_bf16_f32 v53, v113, v113
    v_cvt_pk_bf16_f32 v54, v114, v114
    v_cvt_pk_bf16_f32 v55, v115, v115
    v_and_b32 v36, 0xffff0000, v36
    v_and_b32 v37, 0xffff0000, v37
    v_and_b32 v38, 0xffff0000, v38
    v_and_b32 v39, 0xffff0000, v39
    v_and_b32 v40, 0xffff0000, v40
    v_and_b32 v41, 0xffff0000, v41
    v_and_b32 v42, 0xffff0000, v42
    v_and_b32 v43, 0xffff0000, v43
    v_and_b32 v44, 0xffff0000, v44
    v_and_b32 v45, 0xffff0000, v45
    v_and_b32 v46, 0xffff0000, v46
    v_and_b32 v47, 0xffff0000, v47
    v_and_b32 v48, 0xffff0000, v48
    v_and_b32 v49, 0xffff0000, v49
    v_and_b32 v50, 0xffff0000, v50
    v_and_b32 v51, 0xffff0000, v51
    v_and_b32 v52, 0xffff0000, v52
    v_and_b32 v53, 0xffff0000, v53
    v_and_b32 v54, 0xffff0000, v54
    v_and_b32 v55, 0xffff0000, v55
    v_sub_f32 v56, v88, v36
    v_sub_f32 v57, v89, v37
    v_sub_f32 v58, v90, v38
    v_sub_f32 v59, v91, v39
    v_sub_f32 v60, v92, v40
    v_sub_f32 v61, v93, v41
    v_sub_f32 v62, v94, v42
    v_sub_f32 v63, v95, v43
    v_sub_f32 v64, v96, v44
    v_sub_f32 v65, v97, v45
    v_sub_f32 v66, v98, v46
    v_sub_f32 v67, v99, v47
    v_sub_f32 v68, v100, v48
    v_sub_f32 v69, v101, v49
    v_sub_f32 v70, v102, v50
    v_sub_f32 v71, v103, v51
    v_sub_f32 v72, v112, v52
    v_sub_f32 v73, v113, v53
    v_sub_f32 v74, v114, v54
    v_sub_f32 v75, v115, v55
    v_cvt_pk_bf16_f32 v36, v36, v56
    v_cvt_pk_bf16_f32 v37, v37, v57
    v_cvt_pk_bf16_f32 v38, v38, v58
    v_cvt_pk_bf16_f32 v39, v39, v59
    v_cvt_pk_bf16_f32 v40, v40, v60
    v_cvt_pk_bf16_f32 v41, v41, v61
    v_cvt_pk_bf16_f32 v42, v42, v62
    v_cvt_pk_bf16_f32 v43, v43, v63
    v_cvt_pk_bf16_f32 v44, v44, v64
    v_cvt_pk_bf16_f32 v45, v45, v65
    v_cvt_pk_bf16_f32 v46, v46, v66
    v_cvt_pk_bf16_f32 v47, v47, v67
    v_cvt_pk_bf16_f32 v48, v48, v68
    v_cvt_pk_bf16_f32 v49, v49, v69
    v_cvt_pk_bf16_f32 v50, v50, v70
    v_cvt_pk_bf16_f32 v51, v51, v71
    v_cvt_pk_bf16_f32 v52, v52, v72
    v_cvt_pk_bf16_f32 v53, v53, v73
    v_cvt_pk_bf16_f32 v54, v54, v74
    v_cvt_pk_bf16_f32 v55, v55, v75
    ds_write_b32 v133, v36 offset:1024
    ds_write_b32 v133, v37 offset:1552
    ds_write_b32 v133, v38 offset:2080
    ds_write_b32 v133, v39 offset:2608
    ds_write_b32 v133, v40 offset:5248
    ds_write_b32 v133, v41 offset:5776
    ds_write_b32 v133, v42 offset:6304
    ds_write_b32 v133, v43 offset:6832
    ds_write_b32 v133, v44 offset:9472
    ds_write_b32 v133, v45 offset:10000
    ds_write_b32 v133, v46 offset:10528
    ds_write_b32 v133, v47 offset:11056
    ds_write_b32 v133, v48 offset:13696
    ds_write_b32 v133, v49 offset:14224
    ds_write_b32 v133, v50 offset:14752
    ds_write_b32 v133, v51 offset:15280
    ds_write_b32 v133, v52 offset:17920
    ds_write_b32 v133, v53 offset:18448
    ds_write_b32 v133, v54 offset:18976
    ds_write_b32 v133, v55 offset:19504
K2_uf:
    v_exp_f32 v56, v88
    v_exp_f32 v57, v89
    v_exp_f32 v58, v90
    v_exp_f32 v59, v91
    v_exp_f32 v60, v92
    v_exp_f32 v61, v93
    v_exp_f32 v62, v94
    v_exp_f32 v63, v95
    v_exp_f32 v64, v96
    v_exp_f32 v65, v97
    v_exp_f32 v66, v98
    v_exp_f32 v67, v99
    v_exp_f32 v68, v100
    v_exp_f32 v69, v101
    v_exp_f32 v70, v102
    v_exp_f32 v71, v103
    v_exp_f32 v72, v112
    v_exp_f32 v73, v113
    v_exp_f32 v74, v114
    v_exp_f32 v75, v115
    v_add_f32 v56, 1.0, v56
    v_add_f32 v57, 1.0, v57
    v_add_f32 v58, 1.0, v58
    v_add_f32 v59, 1.0, v59
    v_add_f32 v60, 1.0, v60
    v_add_f32 v61, 1.0, v61
    v_add_f32 v62, 1.0, v62
    v_add_f32 v63, 1.0, v63
    v_add_f32 v64, 1.0, v64
    v_add_f32 v65, 1.0, v65
    v_add_f32 v66, 1.0, v66
    v_add_f32 v67, 1.0, v67
    v_add_f32 v68, 1.0, v68
    v_add_f32 v69, 1.0, v69
    v_add_f32 v70, 1.0, v70
    v_add_f32 v71, 1.0, v71
    v_add_f32 v72, 1.0, v72
    v_add_f32 v73, 1.0, v73
    v_add_f32 v74, 1.0, v74
    v_add_f32 v75, 1.0, v75
    v_rcp_f32 v56, v56
    v_rcp_f32 v57, v57
    v_rcp_f32 v58, v58
    v_rcp_f32 v59, v59
    v_rcp_f32 v60, v60
    v_rcp_f32 v61, v61
    v_rcp_f32 v62, v62
    v_rcp_f32 v63, v63
    v_rcp_f32 v64, v64
    v_rcp_f32 v65, v65
    v_rcp_f32 v66, v66
    v_rcp_f32 v67, v67
    v_rcp_f32 v68, v68
    v_rcp_f32 v69, v69
    v_rcp_f32 v70, v70
    v_rcp_f32 v71, v71
    v_rcp_f32 v72, v72
    v_rcp_f32 v73, v73
    v_rcp_f32 v74, v74
    v_rcp_f32 v75, v75
    s_lshl_b32 s87, s56, 8
    s_movk_i32 s88, 4160
    v_mad_u32_u24 v135, v132, s88, v13
    v_add_u32 v135, s87, v135
    v_mul_f32 v88, v56, v88
    v_mul_f32 v89, v57, v89
    v_mul_f32 v90, v58, v90
    v_mul_f32 v91, v59, v91
    v_mul_f32 v92, v60, v92
    v_mul_f32 v93, v61, v93
    v_mul_f32 v94, v62, v94
    v_mul_f32 v95, v63, v95
    v_mul_f32 v96, v64, v96
    v_mul_f32 v97, v65, v97
    v_mul_f32 v98, v66, v98
    v_mul_f32 v99, v67, v99
    v_mul_f32 v100, v68, v100
    v_mul_f32 v101, v69, v101
    v_mul_f32 v102, v70, v102
    v_mul_f32 v103, v71, v103
    v_mul_f32 v112, v72, v112
    v_mul_f32 v113, v73, v113
    v_mul_f32 v114, v74, v114
    v_mul_f32 v115, v75, v115
    s_waitcnt lgkmcnt(0)
    s_barrier
    ds_read_b32 v124, v134 offset:0
    s_waitcnt lgkmcnt(0)
    v_add_u32 v125, 28, v124
    v_and_b32 v125, -32, v125
    v_mov_b32 v126, v125
    s_nop 1
    v_add_u32_dpp v126, v126, v126 row_shr:1 row_mask:0xf bank_mask:0xf
    s_nop 1
    v_add_u32_dpp v126, v126, v126 row_shr:2 row_mask:0xf bank_mask:0xf
    s_nop 1
    v_add_u32_dpp v126, v126, v126 row_shr:4 row_mask:0xf bank_mask:0xf
    s_nop 1
    v_add_u32_dpp v126, v126, v126 row_shr:8 row_mask:0xf bank_mask:0xf
    s_nop 1
    v_add_u32_dpp v126, v126, v126 row_bcast:15 row_mask:0xa bank_mask:0xf
    s_nop 1
    v_add_u32_dpp v126, v126, v126 row_bcast:31 row_mask:0xc bank_mask:0xf
    s_nop 0
    v_readlane_b32 s89, v126, 63
    v_sub_u32 v126, v126, v125
    v_add_u32 v126, 65536, v126
    s_cmp_gt_u32 s89, 13312
    s_cbranch_scc1 K2_togeneral
    s_add_u32 s87, s89, 127
    s_lshr_b32 s86, s87, 7
    s_lshr_b32 s88, s86, 2
    s_and_b32 s87, s86, 3
    s_mul_i32 s90, s88, s56
    s_min_u32 s91, s56, s87
    s_add_u32 s90, s90, s91
    s_cmp_lt_u32 s56, s87
    s_addc_u32 s35, s88, 0
    v_sub_u32 v125, v125, v124
    v_mov_b32 v16, 0xffffff
    v_lshl_or_b32 v17, v1, 16, 1
    s_lshl_b32 s84, s56, 2
    v_add_u32 v17, 0xfffe, v17
    v_add3_u32 v18, v126, v124, s84
    v_cmpx_lt_u32 vcc, s84, v125
    ds_write2st64_b32 v18, v17, v16 offset0:0 offset1:64
    s_mov_b64 exec, -1
    s_add_u32 s84, s84, 16
    v_add_u32 v19, 16, v18
    v_cmp_lt_u32 vcc, s84, v125
    s_cmp_lg_u32 s56, 3
    s_cbranch_scc1 K2_pad
    s_lshl_b32 s84, s86, 7
    s_add_u32 s85, s89, 65536
    s_sub_u32 s84, s84, s89
    v_mov_b32 v17, 0x28ffff
    v_cmp_gt_u32 vcc, s84, v134
    v_add_u32 v19, s85, v134
K2_pad:
    v_cvt_f32_u32 v125, v125
    v_mul_f32 v125, 0xbe800000, v125
    s_mov_b64 exec, vcc
    ds_write2st64_b32 v19, v17, v16 offset0:0 offset1:64
    s_mov_b64 exec, -1
    ds_write_b32 v134, v125 offset:512
    s_cmp_lg_u32 s56, 0
    s_cbranch_scc1 K2_nocnt
    ds_add_u32 v134, v124 offset:256
K2_nocnt:
    v_lshlrev_b32 v133, 4, v132
    s_waitcnt lgkmcnt(0)
    s_barrier
    ds_read_b128 v[76:79], v133 offset:512
    ds_read_b128 v[80:83], v133 offset:544
    ds_read_b128 v[84:87], v133 offset:576
    ds_read_b128 v[104:107], v133 offset:608
    ds_read_b128 v[108:111], v133 offset:640
    v_mov_b32 v23, 1.0
    s_waitcnt lgkmcnt(0)
    v_mul_legacy_f32 v88, v88, v76
    v_mul_legacy_f32 v89, v89, v77
    v_mul_legacy_f32 v90, v90, v78
    v_mul_legacy_f32 v91, v91, v79
    v_mul_legacy_f32 v92, v92, v80
    v_mul_legacy_f32 v93, v93, v81
    v_mul_legacy_f32 v94, v94, v82
    v_mul_legacy_f32 v95, v95, v83
    v_mul_legacy_f32 v96, v96, v84
    v_mul_legacy_f32 v97, v97, v85
    v_mul_legacy_f32 v98, v98, v86
    v_mul_legacy_f32 v99, v99, v87
    v_mul_legacy_f32 v100, v100, v104
    v_mul_legacy_f32 v101, v101, v105
    v_mul_legacy_f32 v102, v102, v106
    v_mul_legacy_f32 v103, v103, v107
    v_mul_legacy_f32 v112, v112, v108
    v_mul_legacy_f32 v113, v113, v109
    v_mul_legacy_f32 v114, v114, v110
    v_mul_legacy_f32 v115, v115, v111
    v_cvt_f64_f32 v[36:37], v88
    v_cvt_f64_f32 v[38:39], v89
    v_cvt_f64_f32 v[40:41], v90
    v_cvt_f64_f32 v[42:43], v91
    v_cvt_f64_f32 v[44:45], v92
    v_cvt_f64_f32 v[46:47], v93
    v_cvt_f64_f32 v[48:49], v94
    v_cvt_f64_f32 v[50:51], v95
    v_cvt_f64_f32 v[52:53], v96
    v_cvt_f64_f32 v[54:55], v97
    v_cvt_f64_f32 v[56:57], v98
    v_cvt_f64_f32 v[58:59], v99
    v_cvt_f64_f32 v[60:61], v100
    v_cvt_f64_f32 v[62:63], v101
    v_cvt_f64_f32 v[64:65], v102
    v_cvt_f64_f32 v[66:67], v103
    v_cvt_f64_f32 v[68:69], v112
    v_cvt_f64_f32 v[70:71], v113
    v_cvt_f64_f32 v[72:73], v114
    v_cvt_f64_f32 v[74:75], v115
    s_barrier
    s_cmp_eq_u32 s34, 0
    s_cbranch_scc1 K2_cadd
    ds_write_b64 v135, v[36:37] offset:22784
    ds_write_b64 v135, v[38:39] offset:23824
    ds_write_b64 v135, v[40:41] offset:24864
    ds_write_b64 v135, v[42:43] offset:25904
    ds_write_b64 v135, v[44:45] offset:31104
    ds_write_b64 v135, v[46:47] offset:32144
    ds_write_b64 v135, v[48:49] offset:33184
    ds_write_b64 v135, v[50:51] offset:34224
    ds_write_b64 v135, v[52:53] offset:39424
    ds_write_b64 v135, v[54:55] offset:40464
    ds_write_b64 v135, v[56:57] offset:41504
    ds_write_b64 v135, v[58:59] offset:42544
    ds_write_b64 v135, v[60:61] offset:47744
    ds_write_b64 v135, v[62:63] offset:48784
    ds_write_b64 v135, v[64:65] offset:49824
    ds_write_b64 v135, v[66:67] offset:50864
    ds_write_b64 v135, v[68:69] offset:56064
    ds_write_b64 v135, v[70:71] offset:57104
    ds_write_b64 v135, v[72:73] offset:58144
    ds_write_b64 v135, v[74:75] offset:59184
K2_cdone:
    s_waitcnt lgkmcnt(0)
    s_barrier
    s_branch K2_loop_done
K2_rare1:
    s_mov_b64 exec, s[48:49]
    s_cbranch_execz K2_r1a0
    buffer_load_dwordx4 a[80:83], v76, s[12:15], 0 offen offset:96 sc1
K2_r1a0:
    s_mov_b64 exec, s[50:51]
    s_cbranch_execz K2_r1a1
    buffer_load_dwordx4 a[84:87], v77, s[12:15], 0 offen offset:96 sc1
K2_r1a1:
    s_mov_b64 exec, s[52:53]
    s_cbranch_execz K2_r1a2
    buffer_load_dwordx4 a[88:91], v78, s[12:15], 0 offen offset:96 sc1
K2_r1a2:
    s_mov_b64 exec, s[54:55]
    s_cbranch_execz K2_r1a3
    buffer_load_dwordx4 a[92:95], v79, s[12:15], 0 offen offset:96 sc1
K2_r1a3:
    s_mov_b64 exec, -1
    s_branch K2_rare1r
K2_rare1b:
    s_waitcnt vmcnt(0)
    s_mov_b64 exec, s[48:49]
    s_cbranch_execz K2_r1b0
    v_accvgpr_read_b32 v135, a80
    v_cmpx_lt_i32 vcc, 24, v112
    v_and_b32_sdwa v135, v135, s43 dst_sel:DWORD dst_unused:UNUSED_PAD src0_sel:BYTE_3 src1_sel:DWORD
    ds_add_rtn_u32 v120, v135, v133 offset:0
    v_accvgpr_read_b32 v135, a81
    v_cmpx_lt_i32 vcc, 25, v112
    v_and_b32_sdwa v135, v135, s43 dst_sel:DWORD dst_unused:UNUSED_PAD src0_sel:BYTE_3 src1_sel:DWORD
    ds_add_rtn_u32 v121, v135, v133 offset:0
    v_accvgpr_read_b32 v135, a82
    v_cmpx_lt_i32 vcc, 26, v112
    v_and_b32_sdwa v135, v135, s43 dst_sel:DWORD dst_unused:UNUSED_PAD src0_sel:BYTE_3 src1_sel:DWORD
    ds_add_rtn_u32 v122, v135, v133 offset:0
    v_accvgpr_read_b32 v135, a83
    v_cmpx_lt_i32 vcc, 27, v112
    v_and_b32_sdwa v135, v135, s43 dst_sel:DWORD dst_unused:UNUSED_PAD src0_sel:BYTE_3 src1_sel:DWORD
    ds_add_rtn_u32 v123, v135, v133 offset:0
    s_mov_b64 exec, -1
    s_waitcnt lgkmcnt(0)
    v_accvgpr_write_b32 a96, v120
    v_accvgpr_write_b32 a97, v121
    v_accvgpr_write_b32 a98, v122
    v_accvgpr_write_b32 a99, v123
K2_r1b0:
    s_mov_b64 exec, s[50:51]
    s_cbranch_execz K2_r1b1
    v_accvgpr_read_b32 v135, a84
    v_cmpx_lt_i32 vcc, 24, v113
    v_and_b32_sdwa v135, v135, s43 dst_sel:DWORD dst_unused:UNUSED_PAD src0_sel:BYTE_3 src1_sel:DWORD
    ds_add_rtn_u32 v120, v135, v133 offset:0
    v_accvgpr_read_b32 v135, a85
    v_cmpx_lt_i32 vcc, 25, v113
    v_and_b32_sdwa v135, v135, s43 dst_sel:DWORD dst_unused:UNUSED_PAD src0_sel:BYTE_3 src1_sel:DWORD
    ds_add_rtn_u32 v121, v135, v133 offset:0
    v_accvgpr_read_b32 v135, a86
    v_cmpx_lt_i32 vcc, 26, v113
    v_and_b32_sdwa v135, v135, s43 dst_sel:DWORD dst_unused:UNUSED_PAD src0_sel:BYTE_3 src1_sel:DWORD
    ds_add_rtn_u32 v122, v135, v133 offset:0
    v_accvgpr_read_b32 v135, a87
    v_cmpx_lt_i32 vcc, 27, v113
    v_and_b32_sdwa v135, v135, s43 dst_sel:DWORD dst_unused:UNUSED_PAD src0_sel:BYTE_3 src1_sel:DWORD
    ds_add_rtn_u32 v123, v135, v133 offset:0
    s_mov_b64 exec, -1
    s_waitcnt lgkmcnt(0)
    v_accvgpr_write_b32 a100, v120
    v_accvgpr_write_b32 a101, v121
    v_accvgpr_write_b32 a102, v122
    v_accvgpr_write_b32 a103, v123
K2_r1b1:
    s_mov_b64 exec, s[52:53]
    s_cbranch_execz K2_r1b2
    v_accvgpr_read_b32 v135, a88
    v_cmpx_lt_i32 vcc, 24, v114
    v_and_b32_sdwa v135, v135, s43 dst_sel:DWORD dst_unused:UNUSED_PAD src0_sel:BYTE_3 src1_sel:DWORD
    ds_add_rtn_u32 v120, v135, v133 offset:0
    v_accvgpr_read_b32 v135, a89
    v_cmpx_lt_i32 vcc, 25, v114
    v_and_b32_sdwa v135, v135, s43 dst_sel:DWORD dst_unused:UNUSED_PAD src0_sel:BYTE_3 src1_sel:DWORD
    ds_add_rtn_u32 v121, v135, v133 offset:0
    v_accvgpr_read_b32 v135, a90
    v_cmpx_lt_i32 vcc, 26, v114
    v_and_b32_sdwa v135, v135, s43 dst_sel:DWORD dst_unused:UNUSED_PAD src0_sel:BYTE_3 src1_sel:DWORD
    ds_add_rtn_u32 v122, v135, v133 offset:0
    v_accvgpr_read_b32 v135, a91
    v_cmpx_lt_i32 vcc, 27, v114
    v_and_b32_sdwa v135, v135, s43 dst_sel:DWORD dst_unused:UNUSED_PAD src0_sel:BYTE_3 src1_sel:DWORD
    ds_add_rtn_u32 v123, v135, v133 offset:0
    s_mov_b64 exec, -1
    s_waitcnt lgkmcnt(0)
    v_accvgpr_write_b32 a104, v120
    v_accvgpr_write_b32 a105, v121
    v_accvgpr_write_b32 a106, v122
    v_accvgpr_write_b32 a107, v123
K2_r1b2:
    s_mov_b64 exec, s[54:55]
    s_cbranch_execz K2_r1b3
    v_accvgpr_read_b32 v135, a92
    v_cmpx_lt_i32 vcc, 24, v115
    v_and_b32_sdwa v135, v135, s43 dst_sel:DWORD dst_unused:UNUSED_PAD src0_sel:BYTE_3 src1_sel:DWORD
    ds_add_rtn_u32 v120, v135, v133 offset:0
    v_accvgpr_read_b32 v135, a93
    v_cmpx_lt_i32 vcc, 25, v115
    v_and_b32_sdwa v135, v135, s43 dst_sel:DWORD dst_unused:UNUSED_PAD src0_sel:BYTE_3 src1_sel:DWORD
    ds_add_rtn_u32 v121, v135, v133 offset:0
    v_accvgpr_read_b32 v135, a94
    v_cmpx_lt_i32 vcc, 26, v115
    v_and_b32_sdwa v135, v135, s43 dst_sel:DWORD dst_unused:UNUSED_PAD src0_sel:BYTE_3 src1_sel:DWORD
    ds_add_rtn_u32 v122, v135, v133 offset:0
    v_accvgpr_read_b32 v135, a95
    v_cmpx_lt_i32 vcc, 27, v115
    v_and_b32_sdwa v135, v135, s43 dst_sel:DWORD dst_unused:UNUSED_PAD src0_sel:BYTE_3 src1_sel:DWORD
    ds_add_rtn_u32 v123, v135, v133 offset:0
    s_mov_b64 exec, -1
    s_waitcnt lgkmcnt(0)
    v_accvgpr_write_b32 a108, v120
    v_accvgpr_write_b32 a109, v121
    v_accvgpr_write_b32 a110, v122
    v_accvgpr_write_b32 a111, v123
K2_r1b3:
    s_mov_b64 exec, -1
    s_branch K2_rare1br
K2_rare2:
    s_waitcnt lgkmcnt(0)
    s_cmp_eq_u64 s[48:49], 0
    s_cbranch_scc1 K2_r20
    v_accvgpr_read_b32 v16, a80
    v_and_b32_sdwa v56, v16, s43 dst_sel:DWORD dst_unused:UNUSED_PAD src0_sel:BYTE_3 src1_sel:DWORD
    ds_bpermute_b32 v120, v56, v126
    v_accvgpr_read_b32 v17, a81
    v_and_b32_sdwa v57, v17, s43 dst_sel:DWORD dst_unused:UNUSED_PAD src0_sel:BYTE_3 src1_sel:DWORD
    ds_bpermute_b32 v121, v57, v126
    v_accvgpr_read_b32 v18, a82
    v_and_b32_sdwa v58, v18, s43 dst_sel:DWORD dst_unused:UNUSED_PAD src0_sel:BYTE_3 src1_sel:DWORD
    ds_bpermute_b32 v122, v58, v126
    v_accvgpr_read_b32 v19, a83
    v_and_b32_sdwa v59, v19, s43 dst_sel:DWORD dst_unused:UNUSED_PAD src0_sel:BYTE_3 src1_sel:DWORD
    ds_bpermute_b32 v123, v59, v126
    s_waitcnt lgkmcnt(0)
    v_and_b32 v76, 0xfff, v16
    v_bfe_u32 v16, v16, 12, 14
    v_add_u32 v76, v76, v116
    v_mad_u32_u24 v16, v56, s44, v16
    v_accvgpr_read_b32 v135, a96
    v_add_u32 v120, v135, v120
    v_and_b32 v77, 0xfff, v17
    v_bfe_u32 v17, v17, 12, 14
    v_add_u32 v77, v77, v116
    v_mad_u32_u24 v17, v57, s44, v17
    v_accvgpr_read_b32 v135, a97
    v_add_u32 v121, v135, v121
    v_and_b32 v78, 0xfff, v18
    v_bfe_u32 v18, v18, 12, 14
    v_add_u32 v78, v78, v116
    v_mad_u32_u24 v18, v58, s44, v18
    v_accvgpr_read_b32 v135, a98
    v_add_u32 v122, v135, v122
    v_and_b32 v79, 0xfff, v19
    v_bfe_u32 v19, v19, 12, 14
    v_add_u32 v79, v79, v116
    v_mad_u32_u24 v19, v59, s44, v19
    v_accvgpr_read_b32 v135, a99
    v_add_u32 v123, v135, v123
    v_cmpx_lt_i32 vcc, 24, v112
    ds_write2st64_b32 v120, v16, v76 offset0:0 offset1:64
    v_cmpx_lt_i32 vcc, 25, v112
    ds_write2st64_b32 v121, v17, v77 offset0:0 offset1:64
    v_cmpx_lt_i32 vcc, 26, v112
    ds_write2st64_b32 v122, v18, v78 offset0:0 offset1:64
    v_cmpx_lt_i32 vcc, 27, v112
    ds_write2st64_b32 v123, v19, v79 offset0:0 offset1:64
    s_waitcnt lgkmcnt(0)
    s_mov_b64 exec, -1
K2_r20:
    s_cmp_eq_u64 s[50:51], 0
    s_cbranch_scc1 K2_r21
    v_accvgpr_read_b32 v20, a84
    v_and_b32_sdwa v60, v20, s43 dst_sel:DWORD dst_unused:UNUSED_PAD src0_sel:BYTE_3 src1_sel:DWORD
    ds_bpermute_b32 v120, v60, v126
    v_accvgpr_read_b32 v21, a85
    v_and_b32_sdwa v61, v21, s43 dst_sel:DWORD dst_unused:UNUSED_PAD src0_sel:BYTE_3 src1_sel:DWORD
    ds_bpermute_b32 v121, v61, v126
    v_accvgpr_read_b32 v22, a86
    v_and_b32_sdwa v62, v22, s43 dst_sel:DWORD dst_unused:UNUSED_PAD src0_sel:BYTE_3 src1_sel:DWORD
    ds_bpermute_b32 v122, v62, v126
    v_accvgpr_read_b32 v23, a87
    v_and_b32_sdwa v63, v23, s43 dst_sel:DWORD dst_unused:UNUSED_PAD src0_sel:BYTE_3 src1_sel:DWORD
    ds_bpermute_b32 v123, v63, v126
    s_waitcnt lgkmcnt(0)
    v_and_b32 v80, 0xfff, v20
    v_bfe_u32 v20, v20, 12, 14
    v_add_u32 v80, v80, v117
    v_mad_u32_u24 v20, v60, s44, v20
    v_accvgpr_read_b32 v135, a100
    v_add_u32 v120, v135, v120
    v_and_b32 v81, 0xfff, v21
    v_bfe_u32 v21, v21, 12, 14
    v_add_u32 v81, v81, v117
    v_mad_u32_u24 v21, v61, s44, v21
    v_accvgpr_read_b32 v135, a101
    v_add_u32 v121, v135, v121
    v_and_b32 v82, 0xfff, v22
    v_bfe_u32 v22, v22, 12, 14
    v_add_u32 v82, v82, v117
    v_mad_u32_u24 v22, v62, s44, v22
    v_accvgpr_read_b32 v135, a102
    v_add_u32 v122, v135, v122
    v_and_b32 v83, 0xfff, v23
    v_bfe_u32 v23, v23, 12, 14
    v_add_u32 v83, v83, v117
    v_mad_u32_u24 v23, v63, s44, v23
    v_accvgpr_read_b32 v135, a103
    v_add_u32 v123, v135, v123
    v_cmpx_lt_i32 vcc, 24, v113
    ds_write2st64_b32 v120, v20, v80 offset0:0 offset1:64
    v_cmpx_lt_i32 vcc, 25, v113
    ds_write2st64_b32 v121, v21, v81 offset0:0 offset1:64
    v_cmpx_lt_i32 vcc, 26, v113
    ds_write2st64_b32 v122, v22, v82 offset0:0 offset1:64
    v_cmpx_lt_i32 vcc, 27, v113
    ds_write2st64_b32 v123, v23, v83 offset0:0 offset1:64
    s_waitcnt lgkmcnt(0)
    s_mov_b64 exec, -1
K2_r21:
    s_cmp_eq_u64 s[52:53], 0
    s_cbranch_scc1 K2_r22
    v_accvgpr_read_b32 v24, a88
    v_and_b32_sdwa v64, v24, s43 dst_sel:DWORD dst_unused:UNUSED_PAD src0_sel:BYTE_3 src1_sel:DWORD
    ds_bpermute_b32 v120, v64, v126
    v_accvgpr_read_b32 v25, a89
    v_and_b32_sdwa v65, v25, s43 dst_sel:DWORD dst_unused:UNUSED_PAD src0_sel:BYTE_3 src1_sel:DWORD
    ds_bpermute_b32 v121, v65, v126
    v_accvgpr_read_b32 v26, a90
    v_and_b32_sdwa v66, v26, s43 dst_sel:DWORD dst_unused:UNUSED_PAD src0_sel:BYTE_3 src1_sel:DWORD
    ds_bpermute_b32 v122, v66, v126
    v_accvgpr_read_b32 v27, a91
    v_and_b32_sdwa v67, v27, s43 dst_sel:DWORD dst_unused:UNUSED_PAD src0_sel:BYTE_3 src1_sel:DWORD
    ds_bpermute_b32 v123, v67, v126
    s_waitcnt lgkmcnt(0)
    v_and_b32 v84, 0xfff, v24
    v_bfe_u32 v24, v24, 12, 14
    v_add_u32 v84, v84, v118
    v_mad_u32_u24 v24, v64, s44, v24
    v_accvgpr_read_b32 v135, a104
    v_add_u32 v120, v135, v120
    v_and_b32 v85, 0xfff, v25
    v_bfe_u32 v25, v25, 12, 14
    v_add_u32 v85, v85, v118
    v_mad_u32_u24 v25, v65, s44, v25
    v_accvgpr_read_b32 v135, a105
    v_add_u32 v121, v135, v121
    v_and_b32 v86, 0xfff, v26
    v_bfe_u32 v26, v26, 12, 14
    v_add_u32 v86, v86, v118
    v_mad_u32_u24 v26, v66, s44, v26
    v_accvgpr_read_b32 v135, a106
    v_add_u32 v122, v135, v122
    v_and_b32 v87, 0xfff, v27
    v_bfe_u32 v27, v27, 12, 14
    v_add_u32 v87, v87, v118
    v_mad_u32_u24 v27, v67, s44, v27
    v_accvgpr_read_b32 v135, a107
    v_add_u32 v123, v135, v123
    v_cmpx_lt_i32 vcc, 24, v114
    ds_write2st64_b32 v120, v24, v84 offset0:0 offset1:64
    v_cmpx_lt_i32 vcc, 25, v114
    ds_write2st64_b32 v121, v25, v85 offset0:0 offset1:64
    v_cmpx_lt_i32 vcc, 26, v114
    ds_write2st64_b32 v122, v26, v86 offset0:0 offset1:64
    v_cmpx_lt_i32 vcc, 27, v114
    ds_write2st64_b32 v123, v27, v87 offset0:0 offset1:64
    s_waitcnt lgkmcnt(0)
    s_mov_b64 exec, -1
K2_r22:
    s_cmp_eq_u64 s[54:55], 0
    s_cbranch_scc1 K2_r23
    v_accvgpr_read_b32 v28, a92
    v_and_b32_sdwa v68, v28, s43 dst_sel:DWORD dst_unused:UNUSED_PAD src0_sel:BYTE_3 src1_sel:DWORD
    ds_bpermute_b32 v120, v68, v126
    v_accvgpr_read_b32 v29, a93
    v_and_b32_sdwa v69, v29, s43 dst_sel:DWORD dst_unused:UNUSED_PAD src0_sel:BYTE_3 src1_sel:DWORD
    ds_bpermute_b32 v121, v69, v126
    v_accvgpr_read_b32 v30, a94
    v_and_b32_sdwa v70, v30, s43 dst_sel:DWORD dst_unused:UNUSED_PAD src0_sel:BYTE_3 src1_sel:DWORD
    ds_bpermute_b32 v122, v70, v126
    v_accvgpr_read_b32 v31, a95
    v_and_b32_sdwa v71, v31, s43 dst_sel:DWORD dst_unused:UNUSED_PAD src0_sel:BYTE_3 src1_sel:DWORD
    ds_bpermute_b32 v123, v71, v126
    s_waitcnt lgkmcnt(0)
    v_and_b32 v88, 0xfff, v28
    v_bfe_u32 v28, v28, 12, 14
    v_add_u32 v88, v88, v119
    v_mad_u32_u24 v28, v68, s44, v28
    v_accvgpr_read_b32 v135, a108
    v_add_u32 v120, v135, v120
    v_and_b32 v89, 0xfff, v29
    v_bfe_u32 v29, v29, 12, 14
    v_add_u32 v89, v89, v119
    v_mad_u32_u24 v29, v69, s44, v29
    v_accvgpr_read_b32 v135, a109
    v_add_u32 v121, v135, v121
    v_and_b32 v90, 0xfff, v30
    v_bfe_u32 v30, v30, 12, 14
    v_add_u32 v90, v90, v119
    v_mad_u32_u24 v30, v70, s44, v30
    v_accvgpr_read_b32 v135, a110
    v_add_u32 v122, v135, v122
    v_and_b32 v91, 0xfff, v31
    v_bfe_u32 v31, v31, 12, 14
    v_add_u32 v91, v91, v119
    v_mad_u32_u24 v31, v71, s44, v31
    v_accvgpr_read_b32 v135, a111
    v_add_u32 v123, v135, v123
    v_cmpx_lt_i32 vcc, 24, v115
    ds_write2st64_b32 v120, v28, v88 offset0:0 offset1:64
    v_cmpx_lt_i32 vcc, 25, v115
    ds_write2st64_b32 v121, v29, v89 offset0:0 offset1:64
    v_cmpx_lt_i32 vcc, 26, v115
    ds_write2st64_b32 v122, v30, v90 offset0:0 offset1:64
    v_cmpx_lt_i32 vcc, 27, v115
    ds_write2st64_b32 v123, v31, v91 offset0:0 offset1:64
    s_waitcnt lgkmcnt(0)
    s_mov_b64 exec, -1
K2_r23:
    s_branch K2_rare2r
K2_cadd:
    ds_add_f64 v135, v[36:37] offset:22784
    ds_add_f64 v135, v[38:39] offset:23824
    ds_add_f64 v135, v[40:41] offset:24864
    ds_add_f64 v135, v[42:43] offset:25904
    ds_add_f64 v135, v[44:45] offset:31104
    ds_add_f64 v135, v[46:47] offset:32144
    ds_add_f64 v135, v[48:49] offset:33184
    ds_add_f64 v135, v[50:51] offset:34224
    ds_add_f64 v135, v[52:53] offset:39424
    ds_add_f64 v135, v[54:55] offset:40464
    ds_add_f64 v135, v[56:57] offset:41504
    ds_add_f64 v135, v[58:59] offset:42544
    ds_add_f64 v135, v[60:61] offset:47744
    ds_add_f64 v135, v[62:63] offset:48784
    ds_add_f64 v135, v[64:65] offset:49824
    ds_add_f64 v135, v[66:67] offset:50864
    ds_add_f64 v135, v[68:69] offset:56064
    ds_add_f64 v135, v[70:71] offset:57104
    ds_add_f64 v135, v[72:73] offset:58144
    ds_add_f64 v135, v[74:75] offset:59184
    s_branch K2_cdone
F_timeout:
    v_mov_b32 v16, 0
    v_mov_b32 v17, 1
    v_mov_b32 v18, 0x100000
    ds_write_b32 v16, v17 offset:776
    ds_max_u32 v16, v18 offset:252
    s_mov_b32 s88, 0
    s_waitcnt vmcnt(0)
    s_branch K2_got
K2_batch:
    s_mov_b32 s6, 1280000
    s_mov_b32 s10, 20480000
    v_and_b32 v131, 31, v1
    v_lshrrev_b32 v132, 5, v1
    v_lshlrev_b32 v130, 4, v1
    v_lshlrev_b32 v134, 2, v1
    s_cmp_lg_u32 s3, 1
    s_cbranch_scc1 K2_init2
    v_mov_b32 v16, 0
    ds_write_b32 v134, v16 offset:0
    s_cmp_eq_u32 s34, 0
    s_cbranch_scc1 K2_init2
    ds_write_b32 v134, v16 offset:256
    ds_write_b32 v134, v16 offset:768
K2_init2:
    s_waitcnt lgkmcnt(0)
    s_barrier
    v_lshlrev_b32 v5, 2, v131
    v_lshlrev_b32 v13, 3, v131
    v_bfe_u32 v16, v1, 4, 1
    v_lshl_or_b32 v17, v132, 2, v16
    v_and_b32 v18, 7, v1
    v_xor_b32 v2, v17, v18
    v_lshlrev_b32 v2, 4, v2
    v_xor_b32 v3, 32, v2
    v_and_b32 v4, 1, v1
    v_xor_b32 v4, v4, v16
    v_lshlrev_b32 v4, 4, v4
    v_bfe_u32 v16, v131, 2, 1
    v_and_b32 v17, 1, v131
    v_lshrrev_b32 v18, 3, v131
    v_bfe_u32 v19, v131, 1, 1
    v_lshl_add_u32 v18, v18, 1, v19
    v_lshl_add_u32 v19, v16, 1, v17
    v_lshl_add_u32 v19, v19, 3, v18
    v_xor_b32 v10, v132, v17
    v_lshlrev_b32 v10, 4, v10
    v_lshl_add_u32 v10, v19, 5, v10
    v_add_u32 v10, s40, v10
    v_and_b32 v20, 3, v19
    v_lshrrev_b32 v19, 2, v19
    v_lshl_add_u32 v19, v20, 3, v19
    v_lshlrev_b32 v19, 7, v19
    v_add_u32 v19, s36, v19
    v_and_b32 v20, 7, v131
    v_xor_b32 v20, v20, v132
    v_lshl_add_u32 v6, v20, 4, v19
    v_xor_b32 v7, 32, v6
    v_xor_b32 v8, 64, v6
    v_xor_b32 v9, 0x60, v6
    v_cmp_eq_u32 vcc, v16, v132
    v_mov_b32 v14, 0x3f803f80
    v_bfe_u32 v11, v1, 3, 1
    v_cndmask_b32 v14, 0, v14, vcc
    v_cmp_eq_u32 vcc, 1, v17
    v_lshlrev_b32 v11, 4, v11
    v_bfe_u32 v12, v1, 1, 3
    v_cndmask_b32 v15, 0, v14, vcc
    v_cndmask_b32 v14, v14, 0, vcc
    v_lshlrev_b32 v12, 2, v12
    s_cmp_ge_u32 s3, 4
    s_cbranch_scc1 K2_ubatch
    v_lshrrev_b32 v128, 2, v1
    s_lshl_b32 s45, s56, 6
    v_add_u32 v128, s45, v128
    v_and_b32 v129, 3, v1
    v_lshlrev_b32 v129, 2, v129
    v_lshrrev_b32 v127, 2, v129
    v_sub_u32 v127, v127, v129
    v_add_u32 v138, 20, v127
    v_add_u32 v127, 16, v127
    v_add_u32 v129, s32, v129
    s_movk_i32 s87, 2500
    v_mul_u32_u24 v116, s87, v128
    s_movk_i32 s87, 2560
    v_mad_u32_u24 v76, v128, s87, v129
    v_lshlrev_b32 v128, 11, v128
    v_add_u32 v117, 40000, v116
    v_add_u32 v77, 40960, v76
    v_add_u32 v118, 80000, v116
    v_add_u32 v78, 81920, v76
    v_add_u32 v119, 120000, v116
    v_add_u32 v79, 122880, v76
    v_mov_b32 v133, 0x40000000
    s_cmp_eq_u32 s56, s33
    s_cselect_b32 s88, -1, 0
    s_cmp_eq_u32 s31, 0
    s_cselect_b32 s88, -1, s88
    s_lshl_b32 s46, s28, 3
    s_add_u32 s46, s46, 2621440
    s_cmp_eq_u32 s31, 1
    s_cbranch_scc1 K2_off
K2_raw:
    s_mul_i32 s80, s33, 2500
    s_lshl_b32 s81, s80, 2
    v_mov_b32 v135, 40
    v_add_u32 v120, 0, v0
    v_mov_b32 v116, s80
    s_movk_i32 s82, 625
    v_cmp_gt_u32 vcc, s82, v120
    v_lshlrev_b32 v76, 4, v120
    s_mov_b64 s[48:49], 0
    v_cndmask_b32 v112, 0, 4, vcc
    v_cndmask_b32 v76, v133, v76, vcc
    buffer_load_dwordx4 v[36:39], v76, s[72:75], s81 offen
    buffer_load_dwordx4 v[56:59], v76, s[68:71], s81 offen
    v_add_u32 v121, 256, v0
    v_mov_b32 v117, s80
    s_movk_i32 s82, 625
    v_cmp_gt_u32 vcc, s82, v121
    v_lshlrev_b32 v77, 4, v121
    s_mov_b64 s[50:51], 0
    v_cndmask_b32 v113, 0, 4, vcc
    v_cndmask_b32 v77, v133, v77, vcc
    buffer_load_dwordx4 v[40:43], v77, s[72:75], s81 offen
    buffer_load_dwordx4 v[60:63], v77, s[68:71], s81 offen
    v_add_u32 v122, 512, v0
    v_mov_b32 v118, s80
    s_movk_i32 s82, 625
    v_cmp_gt_u32 vcc, s82, v122
    v_lshlrev_b32 v78, 4, v122
    s_mov_b64 s[52:53], 0
    v_cndmask_b32 v114, 0, 4, vcc
    v_cndmask_b32 v78, v133, v78, vcc
    buffer_load_dwordx4 v[44:47], v78, s[72:75], s81 offen
    buffer_load_dwordx4 v[64:67], v78, s[68:71], s81 offen
    v_add_u32 v123, 768, v0
    v_mov_b32 v119, s80
    s_movk_i32 s82, 625
    v_cmp_gt_u32 vcc, s82, v123
    v_lshlrev_b32 v79, 4, v123
    s_mov_b64 s[54:55], 0
    v_cndmask_b32 v115, 0, 4, vcc
    v_cndmask_b32 v79, v133, v79, vcc
    buffer_load_dwordx4 v[48:51], v79, s[72:75], s81 offen
    buffer_load_dwordx4 v[68:71], v79, s[68:71], s81 offen
    s_waitcnt vmcnt(0)
    v_subrev_u32 v36, s29, v36
    v_cmp_gt_u32 vcc, s30, v36
    v_lshl_add_u32 v128, v120, 2, 0
    v_lshl_or_b32 v128, v56, 12, v128
    v_cndmask_b32 v36, v135, v36, vcc
    v_lshl_or_b32 v36, v36, 26, v128
    v_subrev_u32 v37, s29, v37
    v_cmp_gt_u32 vcc, s30, v37
    v_lshl_add_u32 v128, v120, 2, 1
    v_lshl_or_b32 v128, v57, 12, v128
    v_cndmask_b32 v37, v135, v37, vcc
    v_lshl_or_b32 v37, v37, 26, v128
    v_subrev_u32 v38, s29, v38
    v_cmp_gt_u32 vcc, s30, v38
    v_lshl_add_u32 v128, v120, 2, 2
    v_lshl_or_b32 v128, v58, 12, v128
    v_cndmask_b32 v38, v135, v38, vcc
    v_lshl_or_b32 v38, v38, 26, v128
    v_subrev_u32 v39, s29, v39
    v_cmp_gt_u32 vcc, s30, v39
    v_lshl_add_u32 v128, v120, 2, 3
    v_lshl_or_b32 v128, v59, 12, v128
    v_cndmask_b32 v39, v135, v39, vcc
    v_lshl_or_b32 v39, v39, 26, v128
    v_subrev_u32 v40, s29, v40
    v_cmp_gt_u32 vcc, s30, v40
    v_lshl_add_u32 v128, v121, 2, 0
    v_lshl_or_b32 v128, v60, 12, v128
    v_cndmask_b32 v40, v135, v40, vcc
    v_lshl_or_b32 v40, v40, 26, v128
    v_subrev_u32 v41, s29, v41
    v_cmp_gt_u32 vcc, s30, v41
    v_lshl_add_u32 v128, v121, 2, 1
    v_lshl_or_b32 v128, v61, 12, v128
    v_cndmask_b32 v41, v135, v41, vcc
    v_lshl_or_b32 v41, v41, 26, v128
    v_subrev_u32 v42, s29, v42
    v_cmp_gt_u32 vcc, s30, v42
    v_lshl_add_u32 v128, v121, 2, 2
    v_lshl_or_b32 v128, v62, 12, v128
    v_cndmask_b32 v42, v135, v42, vcc
    v_lshl_or_b32 v42, v42, 26, v128
    v_subrev_u32 v43, s29, v43
    v_cmp_gt_u32 vcc, s30, v43
    v_lshl_add_u32 v128, v121, 2, 3
    v_lshl_or_b32 v128, v63, 12, v128
    v_cndmask_b32 v43, v135, v43, vcc
    v_lshl_or_b32 v43, v43, 26, v128
    v_subrev_u32 v44, s29, v44
    v_cmp_gt_u32 vcc, s30, v44
    v_lshl_add_u32 v128, v122, 2, 0
    v_lshl_or_b32 v128, v64, 12, v128
    v_cndmask_b32 v44, v135, v44, vcc
    v_lshl_or_b32 v44, v44, 26, v128
    v_subrev_u32 v45, s29, v45
    v_cmp_gt_u32 vcc, s30, v45
    v_lshl_add_u32 v128, v122, 2, 1
    v_lshl_or_b32 v128, v65, 12, v128
    v_cndmask_b32 v45, v135, v45, vcc
    v_lshl_or_b32 v45, v45, 26, v128
    v_subrev_u32 v46, s29, v46
    v_cmp_gt_u32 vcc, s30, v46
    v_lshl_add_u32 v128, v122, 2, 2
    v_lshl_or_b32 v128, v66, 12, v128
    v_cndmask_b32 v46, v135, v46, vcc
    v_lshl_or_b32 v46, v46, 26, v128
    v_subrev_u32 v47, s29, v47
    v_cmp_gt_u32 vcc, s30, v47
    v_lshl_add_u32 v128, v122, 2, 3
    v_lshl_or_b32 v128, v67, 12, v128
    v_cndmask_b32 v47, v135, v47, vcc
    v_lshl_or_b32 v47, v47, 26, v128
    v_subrev_u32 v48, s29, v48
    v_cmp_gt_u32 vcc, s30, v48
    v_lshl_add_u32 v128, v123, 2, 0
    v_lshl_or_b32 v128, v68, 12, v128
    v_cndmask_b32 v48, v135, v48, vcc
    v_lshl_or_b32 v48, v48, 26, v128
    v_subrev_u32 v49, s29, v49
    v_cmp_gt_u32 vcc, s30, v49
    v_lshl_add_u32 v128, v123, 2, 1
    v_lshl_or_b32 v128, v69, 12, v128
    v_cndmask_b32 v49, v135, v49, vcc
    v_lshl_or_b32 v49, v49, 26, v128
    v_subrev_u32 v50, s29, v50
    v_cmp_gt_u32 vcc, s30, v50
    v_lshl_add_u32 v128, v123, 2, 2
    v_lshl_or_b32 v128, v70, 12, v128
    v_cndmask_b32 v50, v135, v50, vcc
    v_lshl_or_b32 v50, v50, 26, v128
    v_subrev_u32 v51, s29, v51
    v_cmp_gt_u32 vcc, s30, v51
    v_lshl_add_u32 v128, v123, 2, 3
    v_lshl_or_b32 v128, v71, 12, v128
    v_cndmask_b32 v51, v135, v51, vcc
    v_lshl_or_b32 v51, v51, 26, v128
    s_branch K2_chkdone
K2_ubatch:
    s_lshl_b32 s87, s56, 7
    s_movk_i32 s88, 2112
    v_mad_u32_u24 v133, v132, s88, v5
    v_add_u32 v133, s87, v133
    ds_read_b32 v36, v133 offset:1024
    ds_read_b32 v37, v133 offset:1552
    ds_read_b32 v38, v133 offset:2080
    ds_read_b32 v39, v133 offset:2608
    ds_read_b32 v40, v133 offset:5248
    ds_read_b32 v41, v133 offset:5776
    ds_read_b32 v42, v133 offset:6304
    ds_read_b32 v43, v133 offset:6832
    ds_read_b32 v44, v133 offset:9472
    ds_read_b32 v45, v133 offset:10000
    ds_read_b32 v46, v133 offset:10528
    ds_read_b32 v47, v133 offset:11056
    ds_read_b32 v48, v133 offset:13696
    ds_read_b32 v49, v133 offset:14224
    ds_read_b32 v50, v133 offset:14752
    ds_read_b32 v51, v133 offset:15280
    ds_read_b32 v52, v133 offset:17920
    ds_read_b32 v53, v133 offset:18448
    ds_read_b32 v54, v133 offset:18976
    ds_read_b32 v55, v133 offset:19504
    s_waitcnt lgkmcnt(0)
    v_lshlrev_b32 v88, 16, v36
    v_and_b32 v36, 0xffff0000, v36
    v_add_f32 v88, v88, v36
    v_lshlrev_b32 v89, 16, v37
    v_and_b32 v37, 0xffff0000, v37
    v_add_f32 v89, v89, v37
    v_lshlrev_b32 v90, 16, v38
    v_and_b32 v38, 0xffff0000, v38
    v_add_f32 v90, v90, v38
    v_lshlrev_b32 v91, 16, v39
    v_and_b32 v39, 0xffff0000, v39
    v_add_f32 v91, v91, v39
    v_lshlrev_b32 v92, 16, v40
    v_and_b32 v40, 0xffff0000, v40
    v_add_f32 v92, v92, v40
    v_lshlrev_b32 v93, 16, v41
    v_and_b32 v41, 0xffff0000, v41
    v_add_f32 v93, v93, v41
    v_lshlrev_b32 v94, 16, v42
    v_and_b32 v42, 0xffff0000, v42
    v_add_f32 v94, v94, v42
    v_lshlrev_b32 v95, 16, v43
    v_and_b32 v43, 0xffff0000, v43
    v_add_f32 v95, v95, v43
    v_lshlrev_b32 v96, 16, v44
    v_and_b32 v44, 0xffff0000, v44
    v_add_f32 v96, v96, v44
    v_lshlrev_b32 v97, 16, v45
    v_and_b32 v45, 0xffff0000, v45
    v_add_f32 v97, v97, v45
    v_lshlrev_b32 v98, 16, v46
    v_and_b32 v46, 0xffff0000, v46
    v_add_f32 v98, v98, v46
    v_lshlrev_b32 v99, 16, v47
    v_and_b32 v47, 0xffff0000, v47
    v_add_f32 v99, v99, v47
    v_lshlrev_b32 v100, 16, v48
    v_and_b32 v48, 0xffff0000, v48
    v_add_f32 v100, v100, v48
    v_lshlrev_b32 v101, 16, v49
    v_and_b32 v49, 0xffff0000, v49
    v_add_f32 v101, v101, v49
    v_lshlrev_b32 v102, 16, v50
    v_and_b32 v50, 0xffff0000, v50
    v_add_f32 v102, v102, v50
    v_lshlrev_b32 v103, 16, v51
    v_and_b32 v51, 0xffff0000, v51
    v_add_f32 v103, v103, v51
    v_lshlrev_b32 v112, 16, v52
    v_and_b32 v52, 0xffff0000, v52
    v_add_f32 v112, v112, v52
    v_lshlrev_b32 v113, 16, v53
    v_and_b32 v53, 0xffff0000, v53
    v_add_f32 v113, v113, v53
    v_lshlrev_b32 v114, 16, v54
    v_and_b32 v54, 0xffff0000, v54
    v_add_f32 v114, v114, v54
    v_lshlrev_b32 v115, 16, v55
    v_and_b32 v55, 0xffff0000, v55
    v_add_f32 v115, v115, v55
    s_branch K2_uf
.p2align 6
K2_loopD:
    v_mfma_f32_32x32x16_bf16 v[72:87], v[36:39], a[4:7], 0
    buffer_load_dwordx4 v22, s[8:11], 0 offen  lds
    s_nop 0
    s_nop 0
    v_exp_f32 v88, v56
    v_mfma_f32_32x32x16_bf16 v[72:87], v[40:43], a[20:23], v[72:87]
    ds_read_b128 v[24:27], v11 offset:96
    v_exp_f32 v89, v57
    v_exp_f32 v90, v58
    v_exp_f32 v91, v59
    v_mfma_f32_32x32x16_bf16 v[72:87], v[44:47], a[36:39], v[72:87]
    ds_read_b32 v22, v12 offset:16480
    v_exp_f32 v92, v60
    v_exp_f32 v93, v61
    v_exp_f32 v94, v62
    v_mfma_f32_32x32x16_bf16 v[72:87], v[48:51], a[52:55], v[72:87]
    s_mov_b32 m0, s37
    v_exp_f32 v95, v63
    v_exp_f32 v96, v64
    v_exp_f32 v97, v65
    v_mfma_f32_32x32x16_bf16 v[72:87], v[52:55], a[68:71], v[72:87]
    v_exp_f32 v98, v66
    v_exp_f32 v99, v67
    v_exp_f32 v100, v68
    v_mfma_f32_32x32x8_bf16 v[72:87], v[14:15], v[106:107], v[72:87]
    s_waitcnt lgkmcnt(0)
    v_exp_f32 v101, v69
    v_exp_f32 v102, v70
    v_exp_f32 v103, v71
    v_permlane16_swap_b32 v20, v21
    v_mad_u32_u16 v25, v25, s42, v3
    v_mad_u32_u16 v26, v26, s42, v132
    v_pk_add_f32 v[118:119], v[118:119], v[28:29]
    v_pk_add_f32 v[88:89], v[88:89], 1.0 op_sel_hi:[1,0]
    v_rcp_f32 v88, v88
    v_rcp_f32 v89, v89
    s_nop 0
    v_pk_mul_f32 v[28:29], v[56:57], v[88:89]
    v_pk_add_f32 v[90:91], v[90:91], 1.0 op_sel_hi:[1,0]
    v_rcp_f32 v90, v90
    v_rcp_f32 v91, v91
    s_nop 0
    v_pk_fma_f32 v[28:29], v[58:59], v[90:91], v[28:29]
    v_pk_add_f32 v[92:93], v[92:93], 1.0 op_sel_hi:[1,0]
    v_rcp_f32 v92, v92
    v_rcp_f32 v93, v93
    s_nop 0
    v_pk_fma_f32 v[28:29], v[60:61], v[92:93], v[28:29]
    v_pk_add_f32 v[94:95], v[94:95], 1.0 op_sel_hi:[1,0]
    v_rcp_f32 v94, v94
    v_rcp_f32 v95, v95
    s_nop 0
    v_pk_fma_f32 v[28:29], v[62:63], v[94:95], v[28:29]
    v_pk_add_f32 v[96:97], v[96:97], 1.0 op_sel_hi:[1,0]
    v_rcp_f32 v96, v96
    v_rcp_f32 v97, v97
    s_nop 0
    v_pk_fma_f32 v[28:29], v[64:65], v[96:97], v[28:29]
    v_pk_add_f32 v[98:99], v[98:99], 1.0 op_sel_hi:[1,0]
    v_rcp_f32 v98, v98
    v_rcp_f32 v99, v99
    s_nop 0
    v_pk_fma_f32 v[28:29], v[66:67], v[98:99], v[28:29]
    v_pk_add_f32 v[100:101], v[100:101], 1.0 op_sel_hi:[1,0]
    v_rcp_f32 v100, v100
    v_rcp_f32 v101, v101
    s_nop 0
    v_pk_fma_f32 v[28:29], v[68:69], v[100:101], v[28:29]
    v_pk_add_f32 v[102:103], v[102:103], 1.0 op_sel_hi:[1,0]
    v_rcp_f32 v102, v102
    v_rcp_f32 v103, v103
    s_nop 0
    v_pk_fma_f32 v[28:29], v[70:71], v[102:103], v[28:29]
    v_mfma_f32_32x32x16_bf16 v[56:71], v[36:39], a[8:11], 0
    s_cbranch_vccz K2_flD00
    s_mov_b64 exec, vcc
    v_mad_u32_u16 v128, v18, s99, v5 op_sel:[1,0,0,0]
    v_cvt_f64_f32 v[120:121], v112
    v_cvt_f64_f32 v[122:123], v114
    v_cvt_f64_f32 v[124:125], v116
    v_cvt_f64_f32 v[126:127], v118
    ds_add_f64 v16, v[120:121] offset:22784
    ds_add_f64 v16, v[122:123] offset:23040
    ds_add_f64 v16, v[124:125] offset:23296
    ds_add_f64 v16, v[126:127] offset:23552
    ds_read_b32 v110, v128 offset:1408
    v_mov_b32 v112, 0
    v_mov_b32 v114, 0
    v_mov_b32 v116, 0
    v_mov_b32 v118, 0
    v_mad_u32_u16 v16, v18, s100, v13 op_sel:[1,0,0,0]
    s_mov_b64 exec, -1
K2_flD00:
    s_nop 0
    s_nop 0
    v_exp_f32 v88, v72
    v_mfma_f32_32x32x16_bf16 v[56:71], v[40:43], a[24:27], v[56:71]
    s_cmp_eq_u64 s[48:49], 0
    s_cbranch_scc1 K2_flD01
    s_mov_b64 exec, s[48:49]
    v_mad_u32_u16 v129, v19, s99, v5 op_sel:[1,0,0,0]
    v_cvt_f64_f32 v[120:121], v113
    v_cvt_f64_f32 v[122:123], v115
    v_cvt_f64_f32 v[124:125], v117
    v_cvt_f64_f32 v[126:127], v119
    ds_add_f64 v17, v[120:121] offset:22784
    ds_add_f64 v17, v[122:123] offset:23040
    ds_add_f64 v17, v[124:125] offset:23296
    ds_add_f64 v17, v[126:127] offset:23552
    ds_read_b32 v111, v129 offset:1408
    v_mov_b32 v113, 0
    v_mov_b32 v115, 0
    v_mov_b32 v117, 0
    v_mov_b32 v119, 0
    v_mad_u32_u16 v17, v19, s100, v13 op_sel:[1,0,0,0]
    s_mov_b64 exec, -1
K2_flD01:
    v_exp_f32 v89, v73
    v_exp_f32 v90, v74
    v_exp_f32 v91, v75
    v_mfma_f32_32x32x16_bf16 v[56:71], v[44:47], a[40:43], v[56:71]
    s_cmp_gt_u32 s35, 2
    v_exp_f32 v92, v76
    v_exp_f32 v93, v77
    v_exp_f32 v94, v78
    v_mfma_f32_32x32x16_bf16 v[56:71], v[48:51], a[56:59], v[56:71]
    s_cselect_b32 s22, 1283072, 0
    v_exp_f32 v95, v79
    v_exp_f32 v96, v80
    v_exp_f32 v97, v81
    v_mfma_f32_32x32x16_bf16 v[56:71], v[52:55], a[72:75], v[56:71]
    s_cselect_b32 s10, 20480000, 0
    v_exp_f32 v98, v82
    v_exp_f32 v99, v83
    v_exp_f32 v100, v84
    v_mfma_f32_32x32x8_bf16 v[56:71], v[14:15], v[108:109], v[56:71]
    s_waitcnt vmcnt(5) lgkmcnt(0)
    v_exp_f32 v101, v85
    v_exp_f32 v102, v86
    v_exp_f32 v103, v87
    v_cmp_ne_u32_sdwa vcc, v18, v20 src0_sel:WORD_1 src1_sel:WORD_1
    v_cmp_ne_u32_sdwa s[48:49], v19, v21 src0_sel:WORD_1 src1_sel:WORD_1
    v_mov_b64 v[18:19], v[134:135]
    v_pk_add_f32 v[112:113], v[112:113], v[28:29]
    v_pk_add_f32 v[88:89], v[88:89], 1.0 op_sel_hi:[1,0]
    v_rcp_f32 v88, v88
    v_rcp_f32 v89, v89
    s_nop 0
    v_pk_mul_f32 v[28:29], v[72:73], v[88:89]
    v_pk_add_f32 v[90:91], v[90:91], 1.0 op_sel_hi:[1,0]
    v_rcp_f32 v90, v90
    v_rcp_f32 v91, v91
    s_nop 0
    v_pk_fma_f32 v[28:29], v[74:75], v[90:91], v[28:29]
    v_pk_add_f32 v[92:93], v[92:93], 1.0 op_sel_hi:[1,0]
    v_rcp_f32 v92, v92
    v_rcp_f32 v93, v93
    s_nop 0
    v_pk_fma_f32 v[28:29], v[76:77], v[92:93], v[28:29]
    v_pk_add_f32 v[94:95], v[94:95], 1.0 op_sel_hi:[1,0]
    v_rcp_f32 v94, v94
    v_rcp_f32 v95, v95
    s_nop 0
    v_pk_fma_f32 v[28:29], v[78:79], v[94:95], v[28:29]
    v_pk_add_f32 v[96:97], v[96:97], 1.0 op_sel_hi:[1,0]
    v_rcp_f32 v96, v96
    v_rcp_f32 v97, v97
    s_nop 0
    v_pk_fma_f32 v[28:29], v[80:81], v[96:97], v[28:29]
    v_pk_add_f32 v[98:99], v[98:99], 1.0 op_sel_hi:[1,0]
    v_rcp_f32 v98, v98
    v_rcp_f32 v99, v99
    s_nop 0
    v_pk_fma_f32 v[28:29], v[82:83], v[98:99], v[28:29]
    v_pk_add_f32 v[100:101], v[100:101], 1.0 op_sel_hi:[1,0]
    v_rcp_f32 v100, v100
    v_rcp_f32 v101, v101
    s_nop 0
    v_pk_fma_f32 v[28:29], v[84:85], v[100:101], v[28:29]
    v_pk_add_f32 v[102:103], v[102:103], 1.0 op_sel_hi:[1,0]
    v_rcp_f32 v102, v102
    v_rcp_f32 v103, v103
    s_nop 0
    v_pk_fma_f32 v[28:29], v[86:87], v[102:103], v[28:29]
    v_mfma_f32_32x32x16_bf16 v[72:87], v[36:39], a[12:15], 0
    s_cbranch_vccz K2_qlD00
    s_mov_b64 exec, vcc
    v_mad_u32_u16 v128, v20, s99, v5 op_sel:[1,0,0,0]
    ds_read_b32 v104, v128 offset:1024
    ds_read_b32 v106, v128 offset:1152
    ds_read_b32 v108, v128 offset:1280
    s_mov_b64 exec, -1
K2_qlD00:
    ds_read_b128 v[36:39], v6 offset:4096
    s_nop 0
    s_nop 0
    v_exp_f32 v88, v56
    v_mfma_f32_32x32x16_bf16 v[72:87], v[40:43], a[28:31], v[72:87]
    s_cmp_eq_u64 s[48:49], 0
    s_cbranch_scc1 K2_qlD01
    s_mov_b64 exec, s[48:49]
    v_mad_u32_u16 v129, v21, s99, v5 op_sel:[1,0,0,0]
    ds_read_b32 v105, v129 offset:1024
    ds_read_b32 v107, v129 offset:1152
    ds_read_b32 v109, v129 offset:1280
    s_mov_b64 exec, -1
K2_qlD01:
    ds_read_b128 v[40:43], v7 offset:4096
    v_exp_f32 v89, v57
    v_exp_f32 v90, v58
    v_exp_f32 v91, v59
    v_mfma_f32_32x32x16_bf16 v[72:87], v[44:47], a[44:47], v[72:87]
    ds_read_b128 v[44:47], v8 offset:4096
    v_exp_f32 v92, v60
    v_exp_f32 v93, v61
    v_exp_f32 v94, v62
    v_mfma_f32_32x32x16_bf16 v[72:87], v[48:51], a[60:63], v[72:87]
    ds_read_b128 v[48:51], v9 offset:4096
    v_exp_f32 v95, v63
    v_exp_f32 v96, v64
    v_exp_f32 v97, v65
    v_mfma_f32_32x32x16_bf16 v[72:87], v[52:55], a[76:79], v[72:87]
    ds_read_b128 v[52:55], v10 offset:1024
    v_exp_f32 v98, v66
    v_exp_f32 v99, v67
    v_exp_f32 v100, v68
    v_mfma_f32_32x32x8_bf16 v[72:87], v[14:15], v[110:111], v[72:87]
    s_waitcnt lgkmcnt(3)
    v_exp_f32 v101, v69
    v_exp_f32 v102, v70
    v_exp_f32 v103, v71
    v_mov_b32 v134, v24
    v_mov_b32 v135, v24
    v_mad_u32_u16 v24, v24, s42, v2
    v_mad_u32_u16 v27, v27, s42, v133
    v_pk_add_f32 v[114:115], v[114:115], v[28:29]
    v_pk_add_f32 v[88:89], v[88:89], 1.0 op_sel_hi:[1,0]
    v_rcp_f32 v88, v88
    v_rcp_f32 v89, v89
    s_nop 0
    v_pk_mul_f32 v[28:29], v[56:57], v[88:89]
    v_pk_add_f32 v[90:91], v[90:91], 1.0 op_sel_hi:[1,0]
    v_rcp_f32 v90, v90
    v_rcp_f32 v91, v91
    s_nop 0
    v_pk_fma_f32 v[28:29], v[58:59], v[90:91], v[28:29]
    v_pk_add_f32 v[92:93], v[92:93], 1.0 op_sel_hi:[1,0]
    v_rcp_f32 v92, v92
    v_rcp_f32 v93, v93
    s_nop 0
    v_pk_fma_f32 v[28:29], v[60:61], v[92:93], v[28:29]
    v_pk_add_f32 v[94:95], v[94:95], 1.0 op_sel_hi:[1,0]
    v_rcp_f32 v94, v94
    v_rcp_f32 v95, v95
    s_nop 0
    v_pk_fma_f32 v[28:29], v[62:63], v[94:95], v[28:29]
    v_pk_add_f32 v[96:97], v[96:97], 1.0 op_sel_hi:[1,0]
    v_rcp_f32 v96, v96
    v_rcp_f32 v97, v97
    s_nop 0
    v_pk_fma_f32 v[28:29], v[64:65], v[96:97], v[28:29]
    v_pk_add_f32 v[98:99], v[98:99], 1.0 op_sel_hi:[1,0]
    v_rcp_f32 v98, v98
    v_rcp_f32 v99, v99
    s_nop 0
    v_pk_fma_f32 v[28:29], v[66:67], v[98:99], v[28:29]
    v_pk_add_f32 v[100:101], v[100:101], 1.0 op_sel_hi:[1,0]
    v_rcp_f32 v100, v100
    v_rcp_f32 v101, v101
    s_nop 0
    v_pk_fma_f32 v[28:29], v[68:69], v[100:101], v[28:29]
    v_pk_add_f32 v[102:103], v[102:103], 1.0 op_sel_hi:[1,0]
    v_rcp_f32 v102, v102
    v_rcp_f32 v103, v103
    s_nop 0
    v_pk_fma_f32 v[28:29], v[70:71], v[102:103], v[28:29]
    v_mfma_f32_32x32x16_bf16 v[56:71], v[36:39], a[0:3], 0
    s_waitcnt lgkmcnt(0)
    s_nop 0
    s_nop 0
    v_exp_f32 v88, v72
    v_mfma_f32_32x32x16_bf16 v[56:71], v[40:43], a[16:19], v[56:71]
    buffer_load_dwordx4 v24, s[20:23], 0 offen offset:0 lds
    v_exp_f32 v89, v73
    v_exp_f32 v90, v74
    v_exp_f32 v91, v75
    v_mfma_f32_32x32x16_bf16 v[56:71], v[44:47], a[32:35], v[56:71]
    buffer_load_dwordx4 v25, s[20:23], 0 offen offset:1024 lds
    v_exp_f32 v92, v76
    v_exp_f32 v93, v77
    v_exp_f32 v94, v78
    v_mfma_f32_32x32x16_bf16 v[56:71], v[48:51], a[48:51], v[56:71]
    buffer_load_dwordx4 v26, s[20:23], 0 offen offset:2048 lds
    v_exp_f32 v95, v79
    v_exp_f32 v96, v80
    v_exp_f32 v97, v81
    v_mfma_f32_32x32x16_bf16 v[56:71], v[52:55], a[64:67], v[56:71]
    buffer_load_dwordx4 v27, s[20:23], 0 offen offset:3072 lds
    v_exp_f32 v98, v82
    v_exp_f32 v99, v83
    v_exp_f32 v100, v84
    v_mfma_f32_32x32x8_bf16 v[56:71], v[14:15], v[104:105], v[56:71]
    s_mov_b32 m0, s41
    s_sub_u32 s35, s35, 1
    v_exp_f32 v101, v85
    v_exp_f32 v102, v86
    v_exp_f32 v103, v87
    v_lshl_add_u32 v22, v22, 5, v4
    v_pk_add_f32 v[116:117], v[116:117], v[28:29]
    v_pk_add_f32 v[88:89], v[88:89], 1.0 op_sel_hi:[1,0]
    v_rcp_f32 v88, v88
    v_rcp_f32 v89, v89
    s_nop 0
    v_pk_mul_f32 v[28:29], v[72:73], v[88:89]
    v_pk_add_f32 v[90:91], v[90:91], 1.0 op_sel_hi:[1,0]
    v_rcp_f32 v90, v90
    v_rcp_f32 v91, v91
    s_nop 0
    v_pk_fma_f32 v[28:29], v[74:75], v[90:91], v[28:29]
    v_pk_add_f32 v[92:93], v[92:93], 1.0 op_sel_hi:[1,0]
    v_rcp_f32 v92, v92
    v_rcp_f32 v93, v93
    s_nop 0
    v_pk_fma_f32 v[28:29], v[76:77], v[92:93], v[28:29]
    v_pk_add_f32 v[94:95], v[94:95], 1.0 op_sel_hi:[1,0]
    v_rcp_f32 v94, v94
    v_rcp_f32 v95, v95
    s_nop 0
    v_pk_fma_f32 v[28:29], v[78:79], v[94:95], v[28:29]
    v_pk_add_f32 v[96:97], v[96:97], 1.0 op_sel_hi:[1,0]
    v_rcp_f32 v96, v96
    v_rcp_f32 v97, v97
    s_nop 0
    v_pk_fma_f32 v[28:29], v[80:81], v[96:97], v[28:29]
    v_pk_add_f32 v[98:99], v[98:99], 1.0 op_sel_hi:[1,0]
    v_rcp_f32 v98, v98
    v_rcp_f32 v99, v99
    s_nop 0
    v_pk_fma_f32 v[28:29], v[82:83], v[98:99], v[28:29]
    v_pk_add_f32 v[100:101], v[100:101], 1.0 op_sel_hi:[1,0]
    v_rcp_f32 v100, v100
    v_rcp_f32 v101, v101
    s_nop 0
    v_pk_fma_f32 v[28:29], v[84:85], v[100:101], v[28:29]
    v_pk_add_f32 v[102:103], v[102:103], 1.0 op_sel_hi:[1,0]
    v_rcp_f32 v102, v102
    v_rcp_f32 v103, v103
    s_nop 0
    v_pk_fma_f32 v[28:29], v[86:87], v[102:103], v[28:29]
    s_cbranch_scc1 K2_drainD
    v_mfma_f32_32x32x16_bf16 v[72:87], v[36:39], a[4:7], 0
    buffer_load_dwordx4 v22, s[8:11], 0 offen  lds
    s_nop 0
    s_nop 0
    v_exp_f32 v88, v56
    v_mfma_f32_32x32x16_bf16 v[72:87], v[40:43], a[20:23], v[72:87]
    ds_read_b128 v[24:27], v11 offset:128
    v_exp_f32 v89, v57
    v_exp_f32 v90, v58
    v_exp_f32 v91, v59
    v_mfma_f32_32x32x16_bf16 v[72:87], v[44:47], a[36:39], v[72:87]
    ds_read_b32 v22, v12 offset:16512
    v_exp_f32 v92, v60
    v_exp_f32 v93, v61
    v_exp_f32 v94, v62
    v_mfma_f32_32x32x16_bf16 v[72:87], v[48:51], a[52:55], v[72:87]
    s_mov_b32 m0, s36
    v_exp_f32 v95, v63
    v_exp_f32 v96, v64
    v_exp_f32 v97, v65
    v_mfma_f32_32x32x16_bf16 v[72:87], v[52:55], a[68:71], v[72:87]
    v_exp_f32 v98, v66
    v_exp_f32 v99, v67
    v_exp_f32 v100, v68
    v_mfma_f32_32x32x8_bf16 v[72:87], v[14:15], v[106:107], v[72:87]
    s_waitcnt lgkmcnt(0)
    v_exp_f32 v101, v69
    v_exp_f32 v102, v70
    v_exp_f32 v103, v71
    v_permlane16_swap_b32 v18, v19
    v_mad_u32_u16 v25, v25, s42, v3
    v_mad_u32_u16 v26, v26, s42, v132
    v_pk_add_f32 v[118:119], v[118:119], v[28:29]
    v_pk_add_f32 v[88:89], v[88:89], 1.0 op_sel_hi:[1,0]
    v_rcp_f32 v88, v88
    v_rcp_f32 v89, v89
    s_nop 0
    v_pk_mul_f32 v[28:29], v[56:57], v[88:89]
    v_pk_add_f32 v[90:91], v[90:91], 1.0 op_sel_hi:[1,0]
    v_rcp_f32 v90, v90
    v_rcp_f32 v91, v91
    s_nop 0
    v_pk_fma_f32 v[28:29], v[58:59], v[90:91], v[28:29]
    v_pk_add_f32 v[92:93], v[92:93], 1.0 op_sel_hi:[1,0]
    v_rcp_f32 v92, v92
    v_rcp_f32 v93, v93
    s_nop 0
    v_pk_fma_f32 v[28:29], v[60:61], v[92:93], v[28:29]
    v_pk_add_f32 v[94:95], v[94:95], 1.0 op_sel_hi:[1,0]
    v_rcp_f32 v94, v94
    v_rcp_f32 v95, v95
    s_nop 0
    v_pk_fma_f32 v[28:29], v[62:63], v[94:95], v[28:29]
    v_pk_add_f32 v[96:97], v[96:97], 1.0 op_sel_hi:[1,0]
    v_rcp_f32 v96, v96
    v_rcp_f32 v97, v97
    s_nop 0
    v_pk_fma_f32 v[28:29], v[64:65], v[96:97], v[28:29]
    v_pk_add_f32 v[98:99], v[98:99], 1.0 op_sel_hi:[1,0]
    v_rcp_f32 v98, v98
    v_rcp_f32 v99, v99
    s_nop 0
    v_pk_fma_f32 v[28:29], v[66:67], v[98:99], v[28:29]
    v_pk_add_f32 v[100:101], v[100:101], 1.0 op_sel_hi:[1,0]
    v_rcp_f32 v100, v100
    v_rcp_f32 v101, v101
    s_nop 0
    v_pk_fma_f32 v[28:29], v[68:69], v[100:101], v[28:29]
    v_pk_add_f32 v[102:103], v[102:103], 1.0 op_sel_hi:[1,0]
    v_rcp_f32 v102, v102
    v_rcp_f32 v103, v103
    s_nop 0
    v_pk_fma_f32 v[28:29], v[70:71], v[102:103], v[28:29]
    v_mfma_f32_32x32x16_bf16 v[56:71], v[36:39], a[8:11], 0
    s_cbranch_vccz K2_flD10
    s_mov_b64 exec, vcc
    v_mad_u32_u16 v128, v20, s99, v5 op_sel:[1,0,0,0]
    v_cvt_f64_f32 v[120:121], v112
    v_cvt_f64_f32 v[122:123], v114
    v_cvt_f64_f32 v[124:125], v116
    v_cvt_f64_f32 v[126:127], v118
    ds_add_f64 v16, v[120:121] offset:22784
    ds_add_f64 v16, v[122:123] offset:23040
    ds_add_f64 v16, v[124:125] offset:23296
    ds_add_f64 v16, v[126:127] offset:23552
    ds_read_b32 v110, v128 offset:1408
    v_mov_b32 v112, 0
    v_mov_b32 v114, 0
    v_mov_b32 v116, 0
    v_mov_b32 v118, 0
    v_mad_u32_u16 v16, v20, s100, v13 op_sel:[1,0,0,0]
    s_mov_b64 exec, -1
K2_flD10:
    s_nop 0
    s_nop 0
    v_exp_f32 v88, v72
    v_mfma_f32_32x32x16_bf16 v[56:71], v[40:43], a[24:27], v[56:71]
    s_cmp_eq_u64 s[48:49], 0
    s_cbranch_scc1 K2_flD11
    s_mov_b64 exec, s[48:49]
    v_mad_u32_u16 v129, v21, s99, v5 op_sel:[1,0,0,0]
    v_cvt_f64_f32 v[120:121], v113
    v_cvt_f64_f32 v[122:123], v115
    v_cvt_f64_f32 v[124:125], v117
    v_cvt_f64_f32 v[126:127], v119
    ds_add_f64 v17, v[120:121] offset:22784
    ds_add_f64 v17, v[122:123] offset:23040
    ds_add_f64 v17, v[124:125] offset:23296
    ds_add_f64 v17, v[126:127] offset:23552
    ds_read_b32 v111, v129 offset:1408
    v_mov_b32 v113, 0
    v_mov_b32 v115, 0
    v_mov_b32 v117, 0
    v_mov_b32 v119, 0
    v_mad_u32_u16 v17, v21, s100, v13 op_sel:[1,0,0,0]
    s_mov_b64 exec, -1
K2_flD11:
    v_exp_f32 v89, v73
    v_exp_f32 v90, v74
    v_exp_f32 v91, v75
    v_mfma_f32_32x32x16_bf16 v[56:71], v[44:47], a[40:43], v[56:71]
    s_cmp_gt_u32 s35, 2
    v_exp_f32 v92, v76
    v_exp_f32 v93, v77
    v_exp_f32 v94, v78
    v_mfma_f32_32x32x16_bf16 v[56:71], v[48:51], a[56:59], v[56:71]
    s_cselect_b32 s22, 1283072, 0
    v_exp_f32 v95, v79
    v_exp_f32 v96, v80
    v_exp_f32 v97, v81
    v_mfma_f32_32x32x16_bf16 v[56:71], v[52:55], a[72:75], v[56:71]
    s_cselect_b32 s10, 20480000, 0
    v_exp_f32 v98, v82
    v_exp_f32 v99, v83
    v_exp_f32 v100, v84
    v_mfma_f32_32x32x8_bf16 v[56:71], v[14:15], v[108:109], v[56:71]
    s_waitcnt vmcnt(5) lgkmcnt(0)
    v_exp_f32 v101, v85
    v_exp_f32 v102, v86
    v_exp_f32 v103, v87
    v_cmp_ne_u32_sdwa vcc, v18, v20 src0_sel:WORD_1 src1_sel:WORD_1
    v_cmp_ne_u32_sdwa s[48:49], v19, v21 src0_sel:WORD_1 src1_sel:WORD_1
    v_mov_b64 v[20:21], v[134:135]
    v_pk_add_f32 v[112:113], v[112:113], v[28:29]
    v_pk_add_f32 v[88:89], v[88:89], 1.0 op_sel_hi:[1,0]
    v_rcp_f32 v88, v88
    v_rcp_f32 v89, v89
    s_nop 0
    v_pk_mul_f32 v[28:29], v[72:73], v[88:89]
    v_pk_add_f32 v[90:91], v[90:91], 1.0 op_sel_hi:[1,0]
    v_rcp_f32 v90, v90
    v_rcp_f32 v91, v91
    s_nop 0
    v_pk_fma_f32 v[28:29], v[74:75], v[90:91], v[28:29]
    v_pk_add_f32 v[92:93], v[92:93], 1.0 op_sel_hi:[1,0]
    v_rcp_f32 v92, v92
    v_rcp_f32 v93, v93
    s_nop 0
    v_pk_fma_f32 v[28:29], v[76:77], v[92:93], v[28:29]
    v_pk_add_f32 v[94:95], v[94:95], 1.0 op_sel_hi:[1,0]
    v_rcp_f32 v94, v94
    v_rcp_f32 v95, v95
    s_nop 0
    v_pk_fma_f32 v[28:29], v[78:79], v[94:95], v[28:29]
    v_pk_add_f32 v[96:97], v[96:97], 1.0 op_sel_hi:[1,0]
    v_rcp_f32 v96, v96
    v_rcp_f32 v97, v97
    s_nop 0
    v_pk_fma_f32 v[28:29], v[80:81], v[96:97], v[28:29]
    v_pk_add_f32 v[98:99], v[98:99], 1.0 op_sel_hi:[1,0]
    v_rcp_f32 v98, v98
    v_rcp_f32 v99, v99
    s_nop 0
    v_pk_fma_f32 v[28:29], v[82:83], v[98:99], v[28:29]
    v_pk_add_f32 v[100:101], v[100:101], 1.0 op_sel_hi:[1,0]
    v_rcp_f32 v100, v100
    v_rcp_f32 v101, v101
    s_nop 0
    v_pk_fma_f32 v[28:29], v[84:85], v[100:101], v[28:29]
    v_pk_add_f32 v[102:103], v[102:103], 1.0 op_sel_hi:[1,0]
    v_rcp_f32 v102, v102
    v_rcp_f32 v103, v103
    s_nop 0
    v_pk_fma_f32 v[28:29], v[86:87], v[102:103], v[28:29]
    v_mfma_f32_32x32x16_bf16 v[72:87], v[36:39], a[12:15], 0
    s_cbranch_vccz K2_qlD10
    s_mov_b64 exec, vcc
    v_mad_u32_u16 v128, v18, s99, v5 op_sel:[1,0,0,0]
    ds_read_b32 v104, v128 offset:1024
    ds_read_b32 v106, v128 offset:1152
    ds_read_b32 v108, v128 offset:1280
    s_mov_b64 exec, -1
K2_qlD10:
    ds_read_b128 v[36:39], v6 offset:0
    s_nop 0
    s_nop 0
    v_exp_f32 v88, v56
    v_mfma_f32_32x32x16_bf16 v[72:87], v[40:43], a[28:31], v[72:87]
    s_cmp_eq_u64 s[48:49], 0
    s_cbranch_scc1 K2_qlD11
    s_mov_b64 exec, s[48:49]
    v_mad_u32_u16 v129, v19, s99, v5 op_sel:[1,0,0,0]
    ds_read_b32 v105, v129 offset:1024
    ds_read_b32 v107, v129 offset:1152
    ds_read_b32 v109, v129 offset:1280
    s_mov_b64 exec, -1
K2_qlD11:
    ds_read_b128 v[40:43], v7 offset:0
    v_exp_f32 v89, v57
    v_exp_f32 v90, v58
    v_exp_f32 v91, v59
    v_mfma_f32_32x32x16_bf16 v[72:87], v[44:47], a[44:47], v[72:87]
    ds_read_b128 v[44:47], v8 offset:0
    v_exp_f32 v92, v60
    v_exp_f32 v93, v61
    v_exp_f32 v94, v62
    v_mfma_f32_32x32x16_bf16 v[72:87], v[48:51], a[60:63], v[72:87]
    ds_read_b128 v[48:51], v9 offset:0
    v_exp_f32 v95, v63
    v_exp_f32 v96, v64
    v_exp_f32 v97, v65
    v_mfma_f32_32x32x16_bf16 v[72:87], v[52:55], a[76:79], v[72:87]
    ds_read_b128 v[52:55], v10 offset:0
    v_exp_f32 v98, v66
    v_exp_f32 v99, v67
    v_exp_f32 v100, v68
    v_mfma_f32_32x32x8_bf16 v[72:87], v[14:15], v[110:111], v[72:87]
    s_waitcnt lgkmcnt(3)
    v_exp_f32 v101, v69
    v_exp_f32 v102, v70
    v_exp_f32 v103, v71
    v_mov_b32 v134, v24
    v_mov_b32 v135, v24
    v_mad_u32_u16 v24, v24, s42, v2
    v_mad_u32_u16 v27, v27, s42, v133
    v_pk_add_f32 v[114:115], v[114:115], v[28:29]
    v_pk_add_f32 v[88:89], v[88:89], 1.0 op_sel_hi:[1,0]
    v_rcp_f32 v88, v88
    v_rcp_f32 v89, v89
    s_nop 0
    v_pk_mul_f32 v[28:29], v[56:57], v[88:89]
    v_pk_add_f32 v[90:91], v[90:91], 1.0 op_sel_hi:[1,0]
    v_rcp_f32 v90, v90
    v_rcp_f32 v91, v91
    s_nop 0
    v_pk_fma_f32 v[28:29], v[58:59], v[90:91], v[28:29]
    v_pk_add_f32 v[92:93], v[92:93], 1.0 op_sel_hi:[1,0]
    v_rcp_f32 v92, v92
    v_rcp_f32 v93, v93
    s_nop 0
    v_pk_fma_f32 v[28:29], v[60:61], v[92:93], v[28:29]
    v_pk_add_f32 v[94:95], v[94:95], 1.0 op_sel_hi:[1,0]
    v_rcp_f32 v94, v94
    v_rcp_f32 v95, v95
    s_nop 0
    v_pk_fma_f32 v[28:29], v[62:63], v[94:95], v[28:29]
    v_pk_add_f32 v[96:97], v[96:97], 1.0 op_sel_hi:[1,0]
    v_rcp_f32 v96, v96
    v_rcp_f32 v97, v97
    s_nop 0
    v_pk_fma_f32 v[28:29], v[64:65], v[96:97], v[28:29]
    v_pk_add_f32 v[98:99], v[98:99], 1.0 op_sel_hi:[1,0]
    v_rcp_f32 v98, v98
    v_rcp_f32 v99, v99
    s_nop 0
    v_pk_fma_f32 v[28:29], v[66:67], v[98:99], v[28:29]
    v_pk_add_f32 v[100:101], v[100:101], 1.0 op_sel_hi:[1,0]
    v_rcp_f32 v100, v100
    v_rcp_f32 v101, v101
    s_nop 0
    v_pk_fma_f32 v[28:29], v[68:69], v[100:101], v[28:29]
    v_pk_add_f32 v[102:103], v[102:103], 1.0 op_sel_hi:[1,0]
    v_rcp_f32 v102, v102
    v_rcp_f32 v103, v103
    s_nop 0
    v_pk_fma_f32 v[28:29], v[70:71], v[102:103], v[28:29]
    v_mfma_f32_32x32x16_bf16 v[56:71], v[36:39], a[0:3], 0
    s_waitcnt lgkmcnt(0)
    s_nop 0
    s_nop 0
    v_exp_f32 v88, v72
    v_mfma_f32_32x32x16_bf16 v[56:71], v[40:43], a[16:19], v[56:71]
    buffer_load_dwordx4 v24, s[20:23], 0 offen offset:0 lds
    v_exp_f32 v89, v73
    v_exp_f32 v90, v74
    v_exp_f32 v91, v75
    v_mfma_f32_32x32x16_bf16 v[56:71], v[44:47], a[32:35], v[56:71]
    buffer_load_dwordx4 v25, s[20:23], 0 offen offset:1024 lds
    v_exp_f32 v92, v76
    v_exp_f32 v93, v77
    v_exp_f32 v94, v78
    v_mfma_f32_32x32x16_bf16 v[56:71], v[48:51], a[48:51], v[56:71]
    buffer_load_dwordx4 v26, s[20:23], 0 offen offset:2048 lds
    v_exp_f32 v95, v79
    v_exp_f32 v96, v80
    v_exp_f32 v97, v81
    v_mfma_f32_32x32x16_bf16 v[56:71], v[52:55], a[64:67], v[56:71]
    buffer_load_dwordx4 v27, s[20:23], 0 offen offset:3072 lds
    v_exp_f32 v98, v82
    v_exp_f32 v99, v83
    v_exp_f32 v100, v84
    v_mfma_f32_32x32x8_bf16 v[56:71], v[14:15], v[104:105], v[56:71]
    s_mov_b32 m0, s40
    s_sub_u32 s35, s35, 1
    v_exp_f32 v101, v85
    v_exp_f32 v102, v86
    v_exp_f32 v103, v87
    v_lshl_add_u32 v22, v22, 5, v4
    v_add_u32 v11, 64, v11
    v_add_u32 v12, 64, v12
    v_pk_add_f32 v[116:117], v[116:117], v[28:29]
    v_pk_add_f32 v[88:89], v[88:89], 1.0 op_sel_hi:[1,0]
    v_rcp_f32 v88, v88
    v_rcp_f32 v89, v89
    s_nop 0
    v_pk_mul_f32 v[28:29], v[72:73], v[88:89]
    v_pk_add_f32 v[90:91], v[90:91], 1.0 op_sel_hi:[1,0]
    v_rcp_f32 v90, v90
    v_rcp_f32 v91, v91
    s_nop 0
    v_pk_fma_f32 v[28:29], v[74:75], v[90:91], v[28:29]
    v_pk_add_f32 v[92:93], v[92:93], 1.0 op_sel_hi:[1,0]
    v_rcp_f32 v92, v92
    v_rcp_f32 v93, v93
    s_nop 0
    v_pk_fma_f32 v[28:29], v[76:77], v[92:93], v[28:29]
    v_pk_add_f32 v[94:95], v[94:95], 1.0 op_sel_hi:[1,0]
    v_rcp_f32 v94, v94
    v_rcp_f32 v95, v95
    s_nop 0
    v_pk_fma_f32 v[28:29], v[78:79], v[94:95], v[28:29]
    v_pk_add_f32 v[96:97], v[96:97], 1.0 op_sel_hi:[1,0]
    v_rcp_f32 v96, v96
    v_rcp_f32 v97, v97
    s_nop 0
    v_pk_fma_f32 v[28:29], v[80:81], v[96:97], v[28:29]
    v_pk_add_f32 v[98:99], v[98:99], 1.0 op_sel_hi:[1,0]
    v_rcp_f32 v98, v98
    v_rcp_f32 v99, v99
    s_nop 0
    v_pk_fma_f32 v[28:29], v[82:83], v[98:99], v[28:29]
    v_pk_add_f32 v[100:101], v[100:101], 1.0 op_sel_hi:[1,0]
    v_rcp_f32 v100, v100
    v_rcp_f32 v101, v101
    s_nop 0
    v_pk_fma_f32 v[28:29], v[84:85], v[100:101], v[28:29]
    v_pk_add_f32 v[102:103], v[102:103], 1.0 op_sel_hi:[1,0]
    v_rcp_f32 v102, v102
    v_rcp_f32 v103, v103
    s_nop 0
    v_pk_fma_f32 v[28:29], v[86:87], v[102:103], v[28:29]
    s_cbranch_scc0 K2_loopD
K2_drainD:
    v_pk_add_f32 v[118:119], v[118:119], v[28:29]
    v_cvt_f64_f32 v[120:121], v112
    v_cvt_f64_f32 v[122:123], v114
    v_cvt_f64_f32 v[124:125], v116
    v_cvt_f64_f32 v[126:127], v118
    ds_add_f64 v16, v[120:121] offset:22784
    ds_add_f64 v16, v[122:123] offset:23040
    ds_add_f64 v16, v[124:125] offset:23296
    ds_add_f64 v16, v[126:127] offset:23552
    v_cvt_f64_f32 v[88:89], v113
    v_cvt_f64_f32 v[90:91], v115
    v_cvt_f64_f32 v[92:93], v117
    v_cvt_f64_f32 v[94:95], v119
    ds_add_f64 v17, v[88:89] offset:22784
    ds_add_f64 v17, v[90:91] offset:23040
    ds_add_f64 v17, v[92:93] offset:23296
    ds_add_f64 v17, v[94:95] offset:23552
    s_branch K2_loop_done
.section .rodata,"a"
.p2align 6
.amdhsa_kernel standalone__edge_featured_mpnn_mpnn__graph_kernel
  .amdhsa_next_free_vgpr 256
  .amdhsa_next_free_sgpr 102
  .amdhsa_accum_offset 144
  .amdhsa_group_segment_fixed_size 0
  .amdhsa_kernarg_size 88
  .amdhsa_user_sgpr_count 2
  .amdhsa_user_sgpr_kernarg_segment_ptr 1
  .amdhsa_system_sgpr_workgroup_id_x 1
.end_amdhsa_kernel
```
